```python
import torch

def _softmax(x, axis=-1):
    return torch.softmax(x, dim=axis)

def _gelu(x):
    return torch.nn.functional.gelu(x, approximate='tanh')

def _silu(x):
    return torch.nn.functional.silu(x)

def _sigmoid(x):
    return torch.sigmoid(x)

def _layernorm(x, axis=-1, eps=1e-05):
    m = x.mean(dim=axis, keepdim=True)
    v = x.var(dim=axis, keepdim=True, unbiased=False)
    return (x - m) / torch.sqrt(v + eps)

def _scatter_add(tgt, idx, src, axis=0):
    return tgt.clone().index_add_(axis, idx, src)

def _segment_sum(src, seg, n):
    out = torch.zeros((n,) + src.shape[1:], dtype=src.dtype)
    return out.index_add_(0, seg, src)

def _pad(x, pw):
    flat = tuple((v for pair in reversed(pw) for v in pair))
    return torch.nn.functional.pad(x, flat)
kernel_name = 'sequential_preLN__memory_aug_recurrent_mem_tr__mixer_channel_mlp__prompt'

def setup_inputs():

    _w = lambda a: (lambda t: t.to(torch.bfloat16) if t.is_floating_point() else t)(torch.as_tensor(a))

    def _A_setup():
        B, S, Dm = (1, 2048, 640)
        H, Dh = (32, 192)
        M, seg = (8, 32)
        seg = min(seg, S)
        S = S // seg * seg
        return {'x': _w((lambda *s: torch.randn(*s, dtype=torch.bfloat16) * 0.05)(B, S, Dm)), 'mem0': _w((lambda *s: torch.randn(*s, dtype=torch.bfloat16) * 0.2)(B, M, Dm)), 'Wq': _w((lambda *s: torch.randn(*s, dtype=torch.bfloat16) * 1.6)(Dm, H, Dh) * Dm ** (-0.5)), 'Wk': _w((lambda *s: torch.randn(*s, dtype=torch.bfloat16) * 1.6)(Dm, H, Dh) * Dm ** (-0.5)), 'Wv': _w((lambda *s: torch.randn(*s, dtype=torch.bfloat16) * 0.2)(Dm, H, Dh) * Dm ** (-0.5)), 'Wo': _w((lambda *s: torch.randn(*s, dtype=torch.bfloat16) * 0.2)(H, Dh, Dm) * (H * Dh) ** (-0.5)), 'seg_len': seg}
    _A_in = _A_setup()

    def _B_setup():
        B, S, D, F = (1, 2048, 640, 1536)
        return {'x': _w((lambda *s: torch.randn(*s, dtype=torch.bfloat16) * 0.05)(B, S, D)), 'w1': _w((lambda *s: torch.randn(*s, dtype=torch.bfloat16) * 0.8)(D, F) * D ** (-0.5)), 'b1': _w((lambda *s: torch.randn(*s, dtype=torch.bfloat16) * 0.4)(F)), 'w2': _w((lambda *s: torch.randn(*s, dtype=torch.bfloat16) * 0.05)(F, D) * F ** (-0.5)), 'b2': _w((lambda *s: torch.randn(*s, dtype=torch.bfloat16) * 0.05)(D))}
    _B_in = _B_setup()
    return {'A_x': _A_in['x'], 'A_mem0': _A_in['mem0'], 'A_Wq': _A_in['Wq'], 'A_Wk': _A_in['Wk'], 'A_Wv': _A_in['Wv'], 'A_Wo': _A_in['Wo'], 'A_seg_len': _A_in['seg_len'], 'B_x': _B_in['x'], 'B_w1': _B_in['w1'], 'B_b1': _B_in['b1'], 'B_w2': _B_in['w2'], 'B_b2': _B_in['b2']}

def reference(A_x, A_mem0, A_Wq, A_Wk, A_Wv, A_Wo, A_seg_len, B_x, B_w1, B_b1, B_w2, B_b2):

    def _A_ref(x, mem0, Wq, Wk, Wv, Wo, seg_len):
        B, S, Dm = x.shape
        H, Dh = (Wq.shape[1], Wq.shape[2])
        M = mem0.shape[1]
        scale = Dh ** (-0.5)
        n_seg = S // seg_len
        L = M + seg_len
        idx = torch.arange(L)
        mask = (idx[:, None] < M) | (idx[:, None] >= idx[None, :])
        mem = mem0
        outs = []
        for s in range(n_seg):
            xs = x[:, s * seg_len:(s + 1) * seg_len, :].clone()
            h = torch.concatenate([mem, xs], axis=1)
            q = torch.einsum('btd,dhe->bhte', h, Wq)
            k = torch.einsum('btd,dhe->bhte', h, Wk)
            v = torch.einsum('btd,dhe->bhte', h, Wv)
            scores = torch.einsum('bhqe,bhke->bhqk', q, k) * scale
            scores = torch.where(mask[None, None], scores, -1000000000.0)
            p = _softmax(scores, axis=-1)
            o = torch.einsum('bhqk,bhke->bhqe', p, v)
            o = torch.einsum('bhte,hed->btd', o, Wo)
            mem = o[:, :M, :].clone()
            outs.append(o[:, M:, :])
        return torch.concatenate(outs, axis=1)

    def _B_ref(x, w1, b1, w2, b2):
        y = _layernorm(x, axis=-1)
        h = _gelu(torch.einsum('bsd,df->bsf', y, w1) + b1)
        return torch.einsum('bsf,fd->bsd', h, w2) + b2
    x = A_x
    h = x + _A_ref(_layernorm(x, axis=-1), A_mem0, A_Wq, A_Wk, A_Wv, A_Wo, A_seg_len)
    h2 = h + _B_ref(_layernorm(h, axis=-1), B_w1, B_b1, B_w2, B_b2)
    return h2
```

```asm
; @launch kernel=sequential_preLN__memory_aug_recurrent_mem_tr__mixer_channel_mlp__prompt_prep_kernel grid=(1309,1,1) block=(256,1,1) lds=0
; @launch kernel=sequential_preLN__memory_aug_recurrent_mem_tr__mixer_channel_mlp__prompt_qkv_kernel grid=(2304,1,1) block=(256,1,1) lds=73728
; @launch kernel=sequential_preLN__memory_aug_recurrent_mem_tr__mixer_channel_mlp__prompt_chain_kernel grid=(256,1,1) block=(320,1,1) lds=46464
; @launch kernel=sequential_preLN__memory_aug_recurrent_mem_tr__mixer_channel_mlp__prompt_attn_kernel grid=(512,1,1) block=(256,1,1) lds=0
; @launch kernel=sequential_preLN__memory_aug_recurrent_mem_tr__mixer_channel_mlp__prompt_wo_kernel grid=(320,1,1) block=(256,1,1) lds=36864
; @launch kernel=sequential_preLN__memory_aug_recurrent_mem_tr__mixer_channel_mlp__prompt_ln2_kernel grid=(512,1,1) block=(256,1,1) lds=0
; @launch kernel=sequential_preLN__memory_aug_recurrent_mem_tr__mixer_channel_mlp__prompt_mlp1_kernel grid=(192,1,1) block=(256,1,1) lds=73728
; @launch kernel=sequential_preLN__memory_aug_recurrent_mem_tr__mixer_channel_mlp__prompt_mlp2_kernel grid=(320,1,1) block=(256,1,1) lds=36864
.amdgcn_target "amdgcn-amd-amdhsa--gfx950"
.text
    .globl sequential_preLN__memory_aug_recurrent_mem_tr__mixer_channel_mlp__prompt_prep_kernel
    .p2align 8
    .type sequential_preLN__memory_aug_recurrent_mem_tr__mixer_channel_mlp__prompt_prep_kernel,@function
sequential_preLN__memory_aug_recurrent_mem_tr__mixer_channel_mlp__prompt_prep_kernel:
    s_cmp_ge_u32 s2, 1309
    s_cbranch_scc1 Lprep_end
    s_load_dwordx2 s[4:5], s[0:1], 112
    v_and_b32 v1, 63, v0
    v_lshrrev_b32 v2, 6, v0
    s_waitcnt lgkmcnt(0)
    s_mov_b32 s8, s4
    s_and_b32 s9, s5, 0xffff
    s_mov_b32 s10, 0x10000000
    s_mov_b32 s11, 0x00020000
    s_cmp_ge_u32 s2, 512
    s_cbranch_scc1 Lprep_tr
    s_load_dwordx2 s[6:7], s[0:1], 0
    s_waitcnt lgkmcnt(0)
    s_mov_b32 s12, s6
    s_and_b32 s13, s7, 0xffff
    s_mov_b32 s14, 0x280000
    s_mov_b32 s15, 0x00020000
    s_lshl_b32 s3, s2, 2
    v_add_u32 v3, s3, v2
    v_mul_u32_u24 v3, 1280, v3
    v_lshl_add_u32 v3, v1, 2, v3
    v_mov_b32 v4, v3
    buffer_load_dword v20, v3, s[12:15], 0 offen offset:0
    buffer_load_dword v21, v3, s[12:15], 0 offen offset:256
    buffer_load_dword v22, v3, s[12:15], 0 offen offset:512
    buffer_load_dword v23, v3, s[12:15], 0 offen offset:768
    buffer_load_dword v24, v3, s[12:15], 0 offen offset:1024
    s_waitcnt vmcnt(0)
    v_lshlrev_b32 v10, 16, v20
    v_and_b32 v11, 0xffff0000, v20
    v_lshlrev_b32 v12, 16, v21
    v_and_b32 v13, 0xffff0000, v21
    v_lshlrev_b32 v14, 16, v22
    v_and_b32 v15, 0xffff0000, v22
    v_lshlrev_b32 v16, 16, v23
    v_and_b32 v17, 0xffff0000, v23
    v_lshlrev_b32 v18, 16, v24
    v_and_b32 v19, 0xffff0000, v24
    v_add_f32 v26, v10, v11
    v_add_f32 v26, v26, v12
    v_add_f32 v26, v26, v13
    v_add_f32 v26, v26, v14
    v_add_f32 v26, v26, v15
    v_add_f32 v26, v26, v16
    v_add_f32 v26, v26, v17
    v_add_f32 v26, v26, v18
    v_add_f32 v26, v26, v19
    v_xor_b32 v28, 1, v1
    v_lshlrev_b32 v28, 2, v28
    ds_bpermute_b32 v27, v28, v26
    s_waitcnt lgkmcnt(0)
    v_add_f32 v26, v26, v27
    v_xor_b32 v28, 2, v1
    v_lshlrev_b32 v28, 2, v28
    ds_bpermute_b32 v27, v28, v26
    s_waitcnt lgkmcnt(0)
    v_add_f32 v26, v26, v27
    v_xor_b32 v28, 4, v1
    v_lshlrev_b32 v28, 2, v28
    ds_bpermute_b32 v27, v28, v26
    s_waitcnt lgkmcnt(0)
    v_add_f32 v26, v26, v27
    v_xor_b32 v28, 8, v1
    v_lshlrev_b32 v28, 2, v28
    ds_bpermute_b32 v27, v28, v26
    s_waitcnt lgkmcnt(0)
    v_add_f32 v26, v26, v27
    v_xor_b32 v28, 16, v1
    v_lshlrev_b32 v28, 2, v28
    ds_bpermute_b32 v27, v28, v26
    s_waitcnt lgkmcnt(0)
    v_add_f32 v26, v26, v27
    v_xor_b32 v28, 32, v1
    v_lshlrev_b32 v28, 2, v28
    ds_bpermute_b32 v27, v28, v26
    s_waitcnt lgkmcnt(0)
    v_add_f32 v26, v26, v27
    v_mul_f32 v26, 0x3acccccd, v26
    v_mov_b32 v29, 0
    v_sub_f32 v27, v10, v26
    v_fmac_f32 v29, v27, v27
    v_sub_f32 v27, v11, v26
    v_fmac_f32 v29, v27, v27
    v_sub_f32 v27, v12, v26
    v_fmac_f32 v29, v27, v27
    v_sub_f32 v27, v13, v26
    v_fmac_f32 v29, v27, v27
    v_sub_f32 v27, v14, v26
    v_fmac_f32 v29, v27, v27
    v_sub_f32 v27, v15, v26
    v_fmac_f32 v29, v27, v27
    v_sub_f32 v27, v16, v26
    v_fmac_f32 v29, v27, v27
    v_sub_f32 v27, v17, v26
    v_fmac_f32 v29, v27, v27
    v_sub_f32 v27, v18, v26
    v_fmac_f32 v29, v27, v27
    v_sub_f32 v27, v19, v26
    v_fmac_f32 v29, v27, v27
    v_xor_b32 v28, 1, v1
    v_lshlrev_b32 v28, 2, v28
    ds_bpermute_b32 v27, v28, v29
    s_waitcnt lgkmcnt(0)
    v_add_f32 v29, v29, v27
    v_xor_b32 v28, 2, v1
    v_lshlrev_b32 v28, 2, v28
    ds_bpermute_b32 v27, v28, v29
    s_waitcnt lgkmcnt(0)
    v_add_f32 v29, v29, v27
    v_xor_b32 v28, 4, v1
    v_lshlrev_b32 v28, 2, v28
    ds_bpermute_b32 v27, v28, v29
    s_waitcnt lgkmcnt(0)
    v_add_f32 v29, v29, v27
    v_xor_b32 v28, 8, v1
    v_lshlrev_b32 v28, 2, v28
    ds_bpermute_b32 v27, v28, v29
    s_waitcnt lgkmcnt(0)
    v_add_f32 v29, v29, v27
    v_xor_b32 v28, 16, v1
    v_lshlrev_b32 v28, 2, v28
    ds_bpermute_b32 v27, v28, v29
    s_waitcnt lgkmcnt(0)
    v_add_f32 v29, v29, v27
    v_xor_b32 v28, 32, v1
    v_lshlrev_b32 v28, 2, v28
    ds_bpermute_b32 v27, v28, v29
    s_waitcnt lgkmcnt(0)
    v_add_f32 v29, v29, v27
    v_mul_f32 v29, 0x3acccccd, v29
    v_cvt_pk_bf16_f32 v27, v26, v29
    v_lshlrev_b32 v26, 16, v27
    v_and_b32 v29, 0xffff0000, v27
    v_add_f32 v29, 0x3727c5ac, v29
    v_cvt_pk_bf16_f32 v27, v29, v29
    v_lshlrev_b32 v29, 16, v27
    v_sqrt_f32 v29, v29
    s_nop 0
    v_cvt_pk_bf16_f32 v27, v29, v29
    v_lshlrev_b32 v29, 16, v27
    v_rcp_f32 v29, v29
    s_nop 0
    v_sub_f32 v10, v10, v26
    v_sub_f32 v11, v11, v26
    v_cvt_pk_bf16_f32 v27, v10, v11
    v_lshlrev_b32 v10, 16, v27
    v_and_b32 v11, 0xffff0000, v27
    v_mul_f32 v10, v10, v29
    v_mul_f32 v11, v11, v29
    v_cvt_pk_bf16_f32 v20, v10, v11
    v_lshlrev_b32 v10, 16, v20
    v_and_b32 v11, 0xffff0000, v20
    v_sub_f32 v12, v12, v26
    v_sub_f32 v13, v13, v26
    v_cvt_pk_bf16_f32 v27, v12, v13
    v_lshlrev_b32 v12, 16, v27
    v_and_b32 v13, 0xffff0000, v27
    v_mul_f32 v12, v12, v29
    v_mul_f32 v13, v13, v29
    v_cvt_pk_bf16_f32 v21, v12, v13
    v_lshlrev_b32 v12, 16, v21
    v_and_b32 v13, 0xffff0000, v21
    v_sub_f32 v14, v14, v26
    v_sub_f32 v15, v15, v26
    v_cvt_pk_bf16_f32 v27, v14, v15
    v_lshlrev_b32 v14, 16, v27
    v_and_b32 v15, 0xffff0000, v27
    v_mul_f32 v14, v14, v29
    v_mul_f32 v15, v15, v29
    v_cvt_pk_bf16_f32 v22, v14, v15
    v_lshlrev_b32 v14, 16, v22
    v_and_b32 v15, 0xffff0000, v22
    v_sub_f32 v16, v16, v26
    v_sub_f32 v17, v17, v26
    v_cvt_pk_bf16_f32 v27, v16, v17
    v_lshlrev_b32 v16, 16, v27
    v_and_b32 v17, 0xffff0000, v27
    v_mul_f32 v16, v16, v29
    v_mul_f32 v17, v17, v29
    v_cvt_pk_bf16_f32 v23, v16, v17
    v_lshlrev_b32 v16, 16, v23
    v_and_b32 v17, 0xffff0000, v23
    v_sub_f32 v18, v18, v26
    v_sub_f32 v19, v19, v26
    v_cvt_pk_bf16_f32 v27, v18, v19
    v_lshlrev_b32 v18, 16, v27
    v_and_b32 v19, 0xffff0000, v27
    v_mul_f32 v18, v18, v29
    v_mul_f32 v19, v19, v29
    v_cvt_pk_bf16_f32 v24, v18, v19
    v_lshlrev_b32 v18, 16, v24
    v_and_b32 v19, 0xffff0000, v24
    buffer_store_dword v20, v4, s[8:11], 0 offen offset:0
    buffer_store_dword v21, v4, s[8:11], 0 offen offset:256
    buffer_store_dword v22, v4, s[8:11], 0 offen offset:512
    buffer_store_dword v23, v4, s[8:11], 0 offen offset:768
    buffer_store_dword v24, v4, s[8:11], 0 offen offset:1024
    s_branch Lprep_end
Lprep_tr:
    s_cmp_ge_u32 s2, 1052
    s_cbranch_scc1 Lprep_zero
    s_nop 0
    v_readfirstlane_b32 s3, v2
    s_sub_u32 s12, s2, 512
    s_lshl_b32 s12, s12, 2
    s_add_u32 s12, s12, s3
    s_cmp_ge_u32 s12, 1440
    s_cbranch_scc1 Lprep_t1
    s_mul_hi_u32 s19, s12, 0x888889
    s_mul_i32 s17, s19, 480
    s_sub_u32 s17, s12, s17
    s_lshl_b32 s13, s19, 3
    s_add_u32 s13, s13, 16
    s_mov_b32 s14, 640
    s_mov_b32 s15, 6144
    s_mul_i32 s16, s19, 7864320
    s_add_u32 s16, s16, 0x400000
    s_branch Lprep_tgo
Lprep_t1:
    s_cmp_ge_u32 s12, 1920
    s_cbranch_scc1 Lprep_t2
    s_sub_u32 s17, s12, 1440
    s_mov_b32 s13, 40
    s_mov_b32 s14, 6144
    s_mov_b32 s15, 640
    s_mov_b32 s16, 0x1c00000
    s_branch Lprep_tgo
Lprep_t2:
    s_cmp_ge_u32 s12, 2040
    s_cbranch_scc1 Lprep_t3
    s_sub_u32 s17, s12, 1920
    s_mov_b32 s13, 64
    s_mov_b32 s14, 640
    s_mov_b32 s15, 1536
    s_mov_b32 s16, 0x2400000
    s_branch Lprep_tgo
Lprep_t3:
    s_sub_u32 s17, s12, 2040
    s_mov_b32 s13, 80
    s_mov_b32 s14, 1536
    s_mov_b32 s15, 640
    s_mov_b32 s16, 0x2600000
Lprep_tgo:
    s_load_dwordx2 s[6:7], s[0:1], s13
    s_lshr_b32 s18, s14, 6
    s_mov_b32 s20, 0
Lprep_divl:
    s_cmp_lt_u32 s17, s18
    s_cbranch_scc1 Lprep_divd
    s_sub_u32 s17, s17, s18
    s_add_u32 s20, s20, 1
    s_branch Lprep_divl
Lprep_divd:
    s_waitcnt lgkmcnt(0)
    s_mul_i32 s21, s14, s15
    s_lshl_b32 s21, s21, 1
    s_mov_b32 s12, s6
    s_and_b32 s13, s7, 0xffff
    s_mov_b32 s24, s6
    s_and_b32 s25, s7, 0xffff
    s_mov_b32 s26, s21
    s_mov_b32 s27, 0x00020000
    s_lshl_b32 s22, s17, 6
    s_mul_i32 s22, s22, s15
    s_lshl_b32 s23, s20, 7
    s_add_u32 s22, s22, s23
    s_lshl_b32 s22, s22, 1
    v_lshlrev_b32 v3, 2, v1
    v_add_u32 v3, s22, v3
    s_lshl_b32 s28, s15, 1
    s_lshl_b32 s23, s20, 7
    v_lshlrev_b32 v4, 1, v1
    v_add_u32 v4, s23, v4
    v_mul_lo_u32 v4, v4, s14
    s_lshl_b32 s23, s17, 6
    v_add_u32 v4, s23, v4
    v_lshlrev_b32 v4, 1, v4
    v_add_u32 v4, s16, v4
    s_lshl_b32 s29, s14, 1
    v_add_u32 v5, s29, v4
    s_mov_b32 s30, 0x05040100
    s_mov_b32 s31, 0x07060302
    buffer_load_dword v10, v3, s[24:27], 0 offen
    v_add_u32 v3, s28, v3
    buffer_load_dword v11, v3, s[24:27], 0 offen
    v_add_u32 v3, s28, v3
    buffer_load_dword v12, v3, s[24:27], 0 offen
    v_add_u32 v3, s28, v3
    buffer_load_dword v13, v3, s[24:27], 0 offen
    v_add_u32 v3, s28, v3
    buffer_load_dword v14, v3, s[24:27], 0 offen
    v_add_u32 v3, s28, v3
    buffer_load_dword v15, v3, s[24:27], 0 offen
    v_add_u32 v3, s28, v3
    buffer_load_dword v16, v3, s[24:27], 0 offen
    v_add_u32 v3, s28, v3
    buffer_load_dword v17, v3, s[24:27], 0 offen
    v_add_u32 v3, s28, v3
    buffer_load_dword v18, v3, s[24:27], 0 offen
    v_add_u32 v3, s28, v3
    buffer_load_dword v19, v3, s[24:27], 0 offen
    v_add_u32 v3, s28, v3
    buffer_load_dword v20, v3, s[24:27], 0 offen
    v_add_u32 v3, s28, v3
    buffer_load_dword v21, v3, s[24:27], 0 offen
    v_add_u32 v3, s28, v3
    buffer_load_dword v22, v3, s[24:27], 0 offen
    v_add_u32 v3, s28, v3
    buffer_load_dword v23, v3, s[24:27], 0 offen
    v_add_u32 v3, s28, v3
    buffer_load_dword v24, v3, s[24:27], 0 offen
    v_add_u32 v3, s28, v3
    buffer_load_dword v25, v3, s[24:27], 0 offen
    v_add_u32 v3, s28, v3
    buffer_load_dword v26, v3, s[24:27], 0 offen
    v_add_u32 v3, s28, v3
    buffer_load_dword v27, v3, s[24:27], 0 offen
    v_add_u32 v3, s28, v3
    buffer_load_dword v28, v3, s[24:27], 0 offen
    v_add_u32 v3, s28, v3
    buffer_load_dword v29, v3, s[24:27], 0 offen
    v_add_u32 v3, s28, v3
    buffer_load_dword v30, v3, s[24:27], 0 offen
    v_add_u32 v3, s28, v3
    buffer_load_dword v31, v3, s[24:27], 0 offen
    v_add_u32 v3, s28, v3
    buffer_load_dword v32, v3, s[24:27], 0 offen
    v_add_u32 v3, s28, v3
    buffer_load_dword v33, v3, s[24:27], 0 offen
    v_add_u32 v3, s28, v3
    buffer_load_dword v34, v3, s[24:27], 0 offen
    v_add_u32 v3, s28, v3
    buffer_load_dword v35, v3, s[24:27], 0 offen
    v_add_u32 v3, s28, v3
    buffer_load_dword v36, v3, s[24:27], 0 offen
    v_add_u32 v3, s28, v3
    buffer_load_dword v37, v3, s[24:27], 0 offen
    v_add_u32 v3, s28, v3
    buffer_load_dword v38, v3, s[24:27], 0 offen
    v_add_u32 v3, s28, v3
    buffer_load_dword v39, v3, s[24:27], 0 offen
    v_add_u32 v3, s28, v3
    buffer_load_dword v40, v3, s[24:27], 0 offen
    v_add_u32 v3, s28, v3
    buffer_load_dword v41, v3, s[24:27], 0 offen
    v_add_u32 v3, s28, v3
    s_waitcnt vmcnt(0)
    v_perm_b32 v50, v11, v10, s30
    v_perm_b32 v54, v11, v10, s31
    v_perm_b32 v51, v13, v12, s30
    v_perm_b32 v55, v13, v12, s31
    v_perm_b32 v52, v15, v14, s30
    v_perm_b32 v56, v15, v14, s31
    v_perm_b32 v53, v17, v16, s30
    v_perm_b32 v57, v17, v16, s31
    buffer_store_dwordx4 v[50:53], v4, s[8:11], 0 offen offset:0
    buffer_store_dwordx4 v[54:57], v5, s[8:11], 0 offen offset:0
    s_nop 1
    v_perm_b32 v50, v19, v18, s30
    v_perm_b32 v54, v19, v18, s31
    v_perm_b32 v51, v21, v20, s30
    v_perm_b32 v55, v21, v20, s31
    v_perm_b32 v52, v23, v22, s30
    v_perm_b32 v56, v23, v22, s31
    v_perm_b32 v53, v25, v24, s30
    v_perm_b32 v57, v25, v24, s31
    buffer_store_dwordx4 v[50:53], v4, s[8:11], 0 offen offset:16
    buffer_store_dwordx4 v[54:57], v5, s[8:11], 0 offen offset:16
    s_nop 1
    v_perm_b32 v50, v27, v26, s30
    v_perm_b32 v54, v27, v26, s31
    v_perm_b32 v51, v29, v28, s30
    v_perm_b32 v55, v29, v28, s31
    v_perm_b32 v52, v31, v30, s30
    v_perm_b32 v56, v31, v30, s31
    v_perm_b32 v53, v33, v32, s30
    v_perm_b32 v57, v33, v32, s31
    buffer_store_dwordx4 v[50:53], v4, s[8:11], 0 offen offset:32
    buffer_store_dwordx4 v[54:57], v5, s[8:11], 0 offen offset:32
    s_nop 1
    v_perm_b32 v50, v35, v34, s30
    v_perm_b32 v54, v35, v34, s31
    v_perm_b32 v51, v37, v36, s30
    v_perm_b32 v55, v37, v36, s31
    v_perm_b32 v52, v39, v38, s30
    v_perm_b32 v56, v39, v38, s31
    v_perm_b32 v53, v41, v40, s30
    v_perm_b32 v57, v41, v40, s31
    buffer_store_dwordx4 v[50:53], v4, s[8:11], 0 offen offset:48
    buffer_store_dwordx4 v[54:57], v5, s[8:11], 0 offen offset:48
    s_nop 1
    buffer_load_dword v10, v3, s[24:27], 0 offen
    v_add_u32 v3, s28, v3
    buffer_load_dword v11, v3, s[24:27], 0 offen
    v_add_u32 v3, s28, v3
    buffer_load_dword v12, v3, s[24:27], 0 offen
    v_add_u32 v3, s28, v3
    buffer_load_dword v13, v3, s[24:27], 0 offen
    v_add_u32 v3, s28, v3
    buffer_load_dword v14, v3, s[24:27], 0 offen
    v_add_u32 v3, s28, v3
    buffer_load_dword v15, v3, s[24:27], 0 offen
    v_add_u32 v3, s28, v3
    buffer_load_dword v16, v3, s[24:27], 0 offen
    v_add_u32 v3, s28, v3
    buffer_load_dword v17, v3, s[24:27], 0 offen
    v_add_u32 v3, s28, v3
    buffer_load_dword v18, v3, s[24:27], 0 offen
    v_add_u32 v3, s28, v3
    buffer_load_dword v19, v3, s[24:27], 0 offen
    v_add_u32 v3, s28, v3
    buffer_load_dword v20, v3, s[24:27], 0 offen
    v_add_u32 v3, s28, v3
    buffer_load_dword v21, v3, s[24:27], 0 offen
    v_add_u32 v3, s28, v3
    buffer_load_dword v22, v3, s[24:27], 0 offen
    v_add_u32 v3, s28, v3
    buffer_load_dword v23, v3, s[24:27], 0 offen
    v_add_u32 v3, s28, v3
    buffer_load_dword v24, v3, s[24:27], 0 offen
    v_add_u32 v3, s28, v3
    buffer_load_dword v25, v3, s[24:27], 0 offen
    v_add_u32 v3, s28, v3
    buffer_load_dword v26, v3, s[24:27], 0 offen
    v_add_u32 v3, s28, v3
    buffer_load_dword v27, v3, s[24:27], 0 offen
    v_add_u32 v3, s28, v3
    buffer_load_dword v28, v3, s[24:27], 0 offen
    v_add_u32 v3, s28, v3
    buffer_load_dword v29, v3, s[24:27], 0 offen
    v_add_u32 v3, s28, v3
    buffer_load_dword v30, v3, s[24:27], 0 offen
    v_add_u32 v3, s28, v3
    buffer_load_dword v31, v3, s[24:27], 0 offen
    v_add_u32 v3, s28, v3
    buffer_load_dword v32, v3, s[24:27], 0 offen
    v_add_u32 v3, s28, v3
    buffer_load_dword v33, v3, s[24:27], 0 offen
    v_add_u32 v3, s28, v3
    buffer_load_dword v34, v3, s[24:27], 0 offen
    v_add_u32 v3, s28, v3
    buffer_load_dword v35, v3, s[24:27], 0 offen
    v_add_u32 v3, s28, v3
    buffer_load_dword v36, v3, s[24:27], 0 offen
    v_add_u32 v3, s28, v3
    buffer_load_dword v37, v3, s[24:27], 0 offen
    v_add_u32 v3, s28, v3
    buffer_load_dword v38, v3, s[24:27], 0 offen
    v_add_u32 v3, s28, v3
    buffer_load_dword v39, v3, s[24:27], 0 offen
    v_add_u32 v3, s28, v3
    buffer_load_dword v40, v3, s[24:27], 0 offen
    v_add_u32 v3, s28, v3
    buffer_load_dword v41, v3, s[24:27], 0 offen
    v_add_u32 v3, s28, v3
    s_waitcnt vmcnt(0)
    v_perm_b32 v50, v11, v10, s30
    v_perm_b32 v54, v11, v10, s31
    v_perm_b32 v51, v13, v12, s30
    v_perm_b32 v55, v13, v12, s31
    v_perm_b32 v52, v15, v14, s30
    v_perm_b32 v56, v15, v14, s31
    v_perm_b32 v53, v17, v16, s30
    v_perm_b32 v57, v17, v16, s31
    buffer_store_dwordx4 v[50:53], v4, s[8:11], 0 offen offset:64
    buffer_store_dwordx4 v[54:57], v5, s[8:11], 0 offen offset:64
    s_nop 1
    v_perm_b32 v50, v19, v18, s30
    v_perm_b32 v54, v19, v18, s31
    v_perm_b32 v51, v21, v20, s30
    v_perm_b32 v55, v21, v20, s31
    v_perm_b32 v52, v23, v22, s30
    v_perm_b32 v56, v23, v22, s31
    v_perm_b32 v53, v25, v24, s30
    v_perm_b32 v57, v25, v24, s31
    buffer_store_dwordx4 v[50:53], v4, s[8:11], 0 offen offset:80
    buffer_store_dwordx4 v[54:57], v5, s[8:11], 0 offen offset:80
    s_nop 1
    v_perm_b32 v50, v27, v26, s30
    v_perm_b32 v54, v27, v26, s31
    v_perm_b32 v51, v29, v28, s30
    v_perm_b32 v55, v29, v28, s31
    v_perm_b32 v52, v31, v30, s30
    v_perm_b32 v56, v31, v30, s31
    v_perm_b32 v53, v33, v32, s30
    v_perm_b32 v57, v33, v32, s31
    buffer_store_dwordx4 v[50:53], v4, s[8:11], 0 offen offset:96
    buffer_store_dwordx4 v[54:57], v5, s[8:11], 0 offen offset:96
    s_nop 1
    v_perm_b32 v50, v35, v34, s30
    v_perm_b32 v54, v35, v34, s31
    v_perm_b32 v51, v37, v36, s30
    v_perm_b32 v55, v37, v36, s31
    v_perm_b32 v52, v39, v38, s30
    v_perm_b32 v56, v39, v38, s31
    v_perm_b32 v53, v41, v40, s30
    v_perm_b32 v57, v41, v40, s31
    buffer_store_dwordx4 v[50:53], v4, s[8:11], 0 offen offset:112
    buffer_store_dwordx4 v[54:57], v5, s[8:11], 0 offen offset:112
    s_nop 1
    s_branch Lprep_end
Lprep_zero:
    s_sub_u32 s3, s2, 1052
    s_lshl_b32 s3, s3, 14
    s_add_u32 s3, s3, 0xb000000
    v_lshlrev_b32 v3, 4, v0
    v_add_u32 v3, s3, v3
    v_mov_b32 v10, 0
    v_mov_b32 v11, 0
    v_mov_b32 v12, 0
    v_mov_b32 v13, 0
    buffer_store_dwordx4 v[10:13], v3, s[8:11], 0 offen offset:0
    v_add_u32 v4, 0x1000, v3
    buffer_store_dwordx4 v[10:13], v4, s[8:11], 0 offen
    v_add_u32 v4, 0x2000, v3
    buffer_store_dwordx4 v[10:13], v4, s[8:11], 0 offen
    v_add_u32 v4, 0x3000, v3
    buffer_store_dwordx4 v[10:13], v4, s[8:11], 0 offen
Lprep_end:
    s_endpgm
    .globl sequential_preLN__memory_aug_recurrent_mem_tr__mixer_channel_mlp__prompt_qkv_kernel
    .p2align 8
    .type sequential_preLN__memory_aug_recurrent_mem_tr__mixer_channel_mlp__prompt_qkv_kernel,@function
sequential_preLN__memory_aug_recurrent_mem_tr__mixer_channel_mlp__prompt_qkv_kernel:
    s_cmp_ge_u32 s2, 2304
    s_cbranch_scc1 Lqkv_end
    s_load_dwordx2 s[4:5], s[0:1], 112
    s_waitcnt lgkmcnt(0)
    s_mov_b32 s8, s4
    s_and_b32 s9, s5, 0xffff
    s_mov_b32 s10, 0x10000000
    s_mov_b32 s11, 0x00020000
    v_and_b32 v1, 63, v0
    v_lshrrev_b32 v2, 6, v0
    s_mul_hi_u32 s37, s2, 0x10000000
    s_mul_i32 s36, s37, 16
    s_sub_u32 s36, s2, s36
    s_mul_i32 s36, s36, 128
    s_mul_i32 s37, s37, 128
    v_lshrrev_b32 v3, 3, v0
    v_and_b32 v4, 7, v0
    v_add_u32 v5, s36, v3
    s_mov_b32 s38, 1280
    v_mul_lo_u32 v5, v5, s38
    v_lshl_add_u32 v5, v4, 4, v5
    v_add_u32 v48, 0x0, v5
    v_add_u32 v49, 40960, v48
    v_add_u32 v50, 40960, v49
    v_add_u32 v51, 40960, v50
    v_add_u32 v5, s37, v3
    s_mov_b32 s38, 1280
    v_mul_lo_u32 v5, v5, s38
    v_lshl_add_u32 v5, v4, 4, v5
    v_add_u32 v52, 0x400000, v5
    v_add_u32 v53, 40960, v52
    v_add_u32 v54, 40960, v53
    v_add_u32 v55, 40960, v54
    v_mul_u32_u24 v58, 144, v3
    v_lshl_add_u32 v58, v4, 4, v58
    v_add_u32 v59, 18432, v58
    v_and_b32 v6, 31, v1
    v_lshrrev_b32 v7, 5, v1
    v_and_b32 v8, 1, v2
    v_lshrrev_b32 v9, 1, v2
    v_mul_u32_u24 v8, 64, v8
    v_add_u32 v8, v8, v6
    v_mul_u32_u24 v56, 144, v8
    v_lshl_add_u32 v56, v7, 4, v56
    v_mul_u32_u24 v9, 64, v9
    v_add_u32 v9, v9, v6
    v_mul_u32_u24 v57, 144, v9
    v_lshl_add_u32 v57, v7, 4, v57
    v_add_u32 v57, 18432, v57
    s_cmp_ge_u32 s37, 12288
    s_cbranch_scc1 Lqkv_v
    v_mov_b32 v64, 0
    v_mov_b32 v65, 0
    v_mov_b32 v66, 0
    v_mov_b32 v67, 0
    v_mov_b32 v68, 0
    v_mov_b32 v69, 0
    v_mov_b32 v70, 0
    v_mov_b32 v71, 0
    v_mov_b32 v72, 0
    v_mov_b32 v73, 0
    v_mov_b32 v74, 0
    v_mov_b32 v75, 0
    v_mov_b32 v76, 0
    v_mov_b32 v77, 0
    v_mov_b32 v78, 0
    v_mov_b32 v79, 0
    v_mov_b32 v80, 0
    v_mov_b32 v81, 0
    v_mov_b32 v82, 0
    v_mov_b32 v83, 0
    v_mov_b32 v84, 0
    v_mov_b32 v85, 0
    v_mov_b32 v86, 0
    v_mov_b32 v87, 0
    v_mov_b32 v88, 0
    v_mov_b32 v89, 0
    v_mov_b32 v90, 0
    v_mov_b32 v91, 0
    v_mov_b32 v92, 0
    v_mov_b32 v93, 0
    v_mov_b32 v94, 0
    v_mov_b32 v95, 0
    v_mov_b32 v96, 0
    v_mov_b32 v97, 0
    v_mov_b32 v98, 0
    v_mov_b32 v99, 0
    v_mov_b32 v100, 0
    v_mov_b32 v101, 0
    v_mov_b32 v102, 0
    v_mov_b32 v103, 0
    v_mov_b32 v104, 0
    v_mov_b32 v105, 0
    v_mov_b32 v106, 0
    v_mov_b32 v107, 0
    v_mov_b32 v108, 0
    v_mov_b32 v109, 0
    v_mov_b32 v110, 0
    v_mov_b32 v111, 0
    v_mov_b32 v112, 0
    v_mov_b32 v113, 0
    v_mov_b32 v114, 0
    v_mov_b32 v115, 0
    v_mov_b32 v116, 0
    v_mov_b32 v117, 0
    v_mov_b32 v118, 0
    v_mov_b32 v119, 0
    v_mov_b32 v120, 0
    v_mov_b32 v121, 0
    v_mov_b32 v122, 0
    v_mov_b32 v123, 0
    v_mov_b32 v124, 0
    v_mov_b32 v125, 0
    v_mov_b32 v126, 0
    v_mov_b32 v127, 0
    s_mov_b32 s40, 0
    buffer_load_dwordx4 v[128:131], v48, s[8:11], s40 offen
    buffer_load_dwordx4 v[132:135], v49, s[8:11], s40 offen
    buffer_load_dwordx4 v[136:139], v50, s[8:11], s40 offen
    buffer_load_dwordx4 v[140:143], v51, s[8:11], s40 offen
    buffer_load_dwordx4 v[144:147], v52, s[8:11], s40 offen
    buffer_load_dwordx4 v[148:151], v53, s[8:11], s40 offen
    buffer_load_dwordx4 v[152:155], v54, s[8:11], s40 offen
    buffer_load_dwordx4 v[156:159], v55, s[8:11], s40 offen
    s_waitcnt vmcnt(0)
    ds_write_b128 v58, v[128:131] offset:0
    ds_write_b128 v58, v[132:135] offset:4608
    ds_write_b128 v58, v[136:139] offset:9216
    ds_write_b128 v58, v[140:143] offset:13824
    ds_write_b128 v59, v[144:147] offset:0
    ds_write_b128 v59, v[148:151] offset:4608
    ds_write_b128 v59, v[152:155] offset:9216
    ds_write_b128 v59, v[156:159] offset:13824
    s_mov_b32 s40, 128
    buffer_load_dwordx4 v[128:131], v48, s[8:11], s40 offen
    buffer_load_dwordx4 v[132:135], v49, s[8:11], s40 offen
    buffer_load_dwordx4 v[136:139], v50, s[8:11], s40 offen
    buffer_load_dwordx4 v[140:143], v51, s[8:11], s40 offen
    buffer_load_dwordx4 v[144:147], v52, s[8:11], s40 offen
    buffer_load_dwordx4 v[148:151], v53, s[8:11], s40 offen
    buffer_load_dwordx4 v[152:155], v54, s[8:11], s40 offen
    buffer_load_dwordx4 v[156:159], v55, s[8:11], s40 offen
    s_waitcnt lgkmcnt(0)
    s_barrier
    s_mov_b32 s41, 0
Lg_qk_loop:
    ds_read_b128 v[168:171], v56 offset:0
    ds_read_b128 v[172:175], v56 offset:4608
    ds_read_b128 v[176:179], v57 offset:0
    ds_read_b128 v[180:183], v57 offset:4608
    ds_read_b128 v[184:187], v56 offset:32
    ds_read_b128 v[188:191], v56 offset:4640
    ds_read_b128 v[192:195], v57 offset:32
    ds_read_b128 v[196:199], v57 offset:4640
    s_waitcnt lgkmcnt(4)
    v_mfma_f32_32x32x16_bf16 v[64:79], v[176:179], v[168:171], v[64:79]
    v_mfma_f32_32x32x16_bf16 v[80:95], v[180:183], v[168:171], v[80:95]
    v_mfma_f32_32x32x16_bf16 v[96:111], v[176:179], v[172:175], v[96:111]
    v_mfma_f32_32x32x16_bf16 v[112:127], v[180:183], v[172:175], v[112:127]
    ds_read_b128 v[168:171], v56 offset:64
    ds_read_b128 v[172:175], v56 offset:4672
    ds_read_b128 v[176:179], v57 offset:64
    ds_read_b128 v[180:183], v57 offset:4672
    s_waitcnt lgkmcnt(4)
    v_mfma_f32_32x32x16_bf16 v[64:79], v[192:195], v[184:187], v[64:79]
    v_mfma_f32_32x32x16_bf16 v[80:95], v[196:199], v[184:187], v[80:95]
    v_mfma_f32_32x32x16_bf16 v[96:111], v[192:195], v[188:191], v[96:111]
    v_mfma_f32_32x32x16_bf16 v[112:127], v[196:199], v[188:191], v[112:127]
    ds_read_b128 v[184:187], v56 offset:96
    ds_read_b128 v[188:191], v56 offset:4704
    ds_read_b128 v[192:195], v57 offset:96
    ds_read_b128 v[196:199], v57 offset:4704
    s_waitcnt lgkmcnt(4)
    v_mfma_f32_32x32x16_bf16 v[64:79], v[176:179], v[168:171], v[64:79]
    v_mfma_f32_32x32x16_bf16 v[80:95], v[180:183], v[168:171], v[80:95]
    v_mfma_f32_32x32x16_bf16 v[96:111], v[176:179], v[172:175], v[96:111]
    v_mfma_f32_32x32x16_bf16 v[112:127], v[180:183], v[172:175], v[112:127]
    s_waitcnt lgkmcnt(0)
    v_mfma_f32_32x32x16_bf16 v[64:79], v[192:195], v[184:187], v[64:79]
    v_mfma_f32_32x32x16_bf16 v[80:95], v[196:199], v[184:187], v[80:95]
    v_mfma_f32_32x32x16_bf16 v[96:111], v[192:195], v[188:191], v[96:111]
    v_mfma_f32_32x32x16_bf16 v[112:127], v[196:199], v[188:191], v[112:127]
    s_waitcnt vmcnt(0)
    ds_write_b128 v58, v[128:131] offset:36864
    ds_write_b128 v58, v[132:135] offset:41472
    ds_write_b128 v58, v[136:139] offset:46080
    ds_write_b128 v58, v[140:143] offset:50688
    ds_write_b128 v59, v[144:147] offset:36864
    ds_write_b128 v59, v[148:151] offset:41472
    ds_write_b128 v59, v[152:155] offset:46080
    ds_write_b128 v59, v[156:159] offset:50688
    s_add_u32 s40, s40, 128
    buffer_load_dwordx4 v[128:131], v48, s[8:11], s40 offen
    buffer_load_dwordx4 v[132:135], v49, s[8:11], s40 offen
    buffer_load_dwordx4 v[136:139], v50, s[8:11], s40 offen
    buffer_load_dwordx4 v[140:143], v51, s[8:11], s40 offen
    buffer_load_dwordx4 v[144:147], v52, s[8:11], s40 offen
    buffer_load_dwordx4 v[148:151], v53, s[8:11], s40 offen
    buffer_load_dwordx4 v[152:155], v54, s[8:11], s40 offen
    buffer_load_dwordx4 v[156:159], v55, s[8:11], s40 offen
    s_waitcnt lgkmcnt(0)
    s_barrier
    ds_read_b128 v[168:171], v56 offset:36864
    ds_read_b128 v[172:175], v56 offset:41472
    ds_read_b128 v[176:179], v57 offset:36864
    ds_read_b128 v[180:183], v57 offset:41472
    ds_read_b128 v[184:187], v56 offset:36896
    ds_read_b128 v[188:191], v56 offset:41504
    ds_read_b128 v[192:195], v57 offset:36896
    ds_read_b128 v[196:199], v57 offset:41504
    s_waitcnt lgkmcnt(4)
    v_mfma_f32_32x32x16_bf16 v[64:79], v[176:179], v[168:171], v[64:79]
    v_mfma_f32_32x32x16_bf16 v[80:95], v[180:183], v[168:171], v[80:95]
    v_mfma_f32_32x32x16_bf16 v[96:111], v[176:179], v[172:175], v[96:111]
    v_mfma_f32_32x32x16_bf16 v[112:127], v[180:183], v[172:175], v[112:127]
    ds_read_b128 v[168:171], v56 offset:36928
    ds_read_b128 v[172:175], v56 offset:41536
    ds_read_b128 v[176:179], v57 offset:36928
    ds_read_b128 v[180:183], v57 offset:41536
    s_waitcnt lgkmcnt(4)
    v_mfma_f32_32x32x16_bf16 v[64:79], v[192:195], v[184:187], v[64:79]
    v_mfma_f32_32x32x16_bf16 v[80:95], v[196:199], v[184:187], v[80:95]
    v_mfma_f32_32x32x16_bf16 v[96:111], v[192:195], v[188:191], v[96:111]
    v_mfma_f32_32x32x16_bf16 v[112:127], v[196:199], v[188:191], v[112:127]
    ds_read_b128 v[184:187], v56 offset:36960
    ds_read_b128 v[188:191], v56 offset:41568
    ds_read_b128 v[192:195], v57 offset:36960
    ds_read_b128 v[196:199], v57 offset:41568
    s_waitcnt lgkmcnt(4)
    v_mfma_f32_32x32x16_bf16 v[64:79], v[176:179], v[168:171], v[64:79]
    v_mfma_f32_32x32x16_bf16 v[80:95], v[180:183], v[168:171], v[80:95]
    v_mfma_f32_32x32x16_bf16 v[96:111], v[176:179], v[172:175], v[96:111]
    v_mfma_f32_32x32x16_bf16 v[112:127], v[180:183], v[172:175], v[112:127]
    s_waitcnt lgkmcnt(0)
    v_mfma_f32_32x32x16_bf16 v[64:79], v[192:195], v[184:187], v[64:79]
    v_mfma_f32_32x32x16_bf16 v[80:95], v[196:199], v[184:187], v[80:95]
    v_mfma_f32_32x32x16_bf16 v[96:111], v[192:195], v[188:191], v[96:111]
    v_mfma_f32_32x32x16_bf16 v[112:127], v[196:199], v[188:191], v[112:127]
    s_waitcnt vmcnt(0)
    ds_write_b128 v58, v[128:131] offset:0
    ds_write_b128 v58, v[132:135] offset:4608
    ds_write_b128 v58, v[136:139] offset:9216
    ds_write_b128 v58, v[140:143] offset:13824
    ds_write_b128 v59, v[144:147] offset:0
    ds_write_b128 v59, v[148:151] offset:4608
    ds_write_b128 v59, v[152:155] offset:9216
    ds_write_b128 v59, v[156:159] offset:13824
    s_add_u32 s40, s40, 128
    buffer_load_dwordx4 v[128:131], v48, s[8:11], s40 offen
    buffer_load_dwordx4 v[132:135], v49, s[8:11], s40 offen
    buffer_load_dwordx4 v[136:139], v50, s[8:11], s40 offen
    buffer_load_dwordx4 v[140:143], v51, s[8:11], s40 offen
    buffer_load_dwordx4 v[144:147], v52, s[8:11], s40 offen
    buffer_load_dwordx4 v[148:151], v53, s[8:11], s40 offen
    buffer_load_dwordx4 v[152:155], v54, s[8:11], s40 offen
    buffer_load_dwordx4 v[156:159], v55, s[8:11], s40 offen
    s_waitcnt lgkmcnt(0)
    s_barrier
    s_add_u32 s41, s41, 2
    s_cmp_lt_u32 s41, 10
    s_cbranch_scc1 Lg_qk_loop
    s_waitcnt vmcnt(0)
    s_nop 15
    s_nop 15
    v_add_u32 v10, s36, v8
    s_mov_b32 s38, 12288
    v_mul_lo_u32 v10, v10, s38
    v_lshrrev_b32 v11, 1, v2
    v_lshlrev_b32 v11, 6, v11
    v_lshl_add_u32 v11, v7, 2, v11
    s_cmp_ge_u32 s37, 6144
    s_cselect_b32 s39, 6144, 0
    s_sub_u32 s39, s37, s39
    v_add_u32 v11, s39, v11
    v_lshlrev_b32 v11, 1, v11
    v_add_u32 v10, v10, v11
    s_mov_b32 s39, 0x3000000
    s_cmp_ge_u32 s37, 6144
    s_cselect_b32 s39, 0x4800000, s39
    v_add_u32 v10, s39, v10
    v_cvt_pk_bf16_f32 v12, v64, v65
    v_cvt_pk_bf16_f32 v13, v66, v67
    buffer_store_dwordx2 v[12:13], v10, s[8:11], 0 offen offset:0
    s_nop 0
    v_cvt_pk_bf16_f32 v12, v68, v69
    v_cvt_pk_bf16_f32 v13, v70, v71
    buffer_store_dwordx2 v[12:13], v10, s[8:11], 0 offen offset:16
    s_nop 0
    v_cvt_pk_bf16_f32 v12, v72, v73
    v_cvt_pk_bf16_f32 v13, v74, v75
    buffer_store_dwordx2 v[12:13], v10, s[8:11], 0 offen offset:32
    s_nop 0
    v_cvt_pk_bf16_f32 v12, v76, v77
    v_cvt_pk_bf16_f32 v13, v78, v79
    buffer_store_dwordx2 v[12:13], v10, s[8:11], 0 offen offset:48
    s_nop 0
    v_cvt_pk_bf16_f32 v12, v80, v81
    v_cvt_pk_bf16_f32 v13, v82, v83
    buffer_store_dwordx2 v[12:13], v10, s[8:11], 0 offen offset:64
    s_nop 0
    v_cvt_pk_bf16_f32 v12, v84, v85
    v_cvt_pk_bf16_f32 v13, v86, v87
    buffer_store_dwordx2 v[12:13], v10, s[8:11], 0 offen offset:80
    s_nop 0
    v_cvt_pk_bf16_f32 v12, v88, v89
    v_cvt_pk_bf16_f32 v13, v90, v91
    buffer_store_dwordx2 v[12:13], v10, s[8:11], 0 offen offset:96
    s_nop 0
    v_cvt_pk_bf16_f32 v12, v92, v93
    v_cvt_pk_bf16_f32 v13, v94, v95
    buffer_store_dwordx2 v[12:13], v10, s[8:11], 0 offen offset:112
    s_nop 0
    v_add_u32 v10, 393216, v10
    v_cvt_pk_bf16_f32 v12, v96, v97
    v_cvt_pk_bf16_f32 v13, v98, v99
    buffer_store_dwordx2 v[12:13], v10, s[8:11], 0 offen offset:0
    s_nop 0
    v_cvt_pk_bf16_f32 v12, v100, v101
    v_cvt_pk_bf16_f32 v13, v102, v103
    buffer_store_dwordx2 v[12:13], v10, s[8:11], 0 offen offset:16
    s_nop 0
    v_cvt_pk_bf16_f32 v12, v104, v105
    v_cvt_pk_bf16_f32 v13, v106, v107
    buffer_store_dwordx2 v[12:13], v10, s[8:11], 0 offen offset:32
    s_nop 0
    v_cvt_pk_bf16_f32 v12, v108, v109
    v_cvt_pk_bf16_f32 v13, v110, v111
    buffer_store_dwordx2 v[12:13], v10, s[8:11], 0 offen offset:48
    s_nop 0
    v_cvt_pk_bf16_f32 v12, v112, v113
    v_cvt_pk_bf16_f32 v13, v114, v115
    buffer_store_dwordx2 v[12:13], v10, s[8:11], 0 offen offset:64
    s_nop 0
    v_cvt_pk_bf16_f32 v12, v116, v117
    v_cvt_pk_bf16_f32 v13, v118, v119
    buffer_store_dwordx2 v[12:13], v10, s[8:11], 0 offen offset:80
    s_nop 0
    v_cvt_pk_bf16_f32 v12, v120, v121
    v_cvt_pk_bf16_f32 v13, v122, v123
    buffer_store_dwordx2 v[12:13], v10, s[8:11], 0 offen offset:96
    s_nop 0
    v_cvt_pk_bf16_f32 v12, v124, v125
    v_cvt_pk_bf16_f32 v13, v126, v127
    buffer_store_dwordx2 v[12:13], v10, s[8:11], 0 offen offset:112
    s_nop 0
    s_branch Lqkv_end
Lqkv_v:
    v_mov_b32 v64, 0
    v_mov_b32 v65, 0
    v_mov_b32 v66, 0
    v_mov_b32 v67, 0
    v_mov_b32 v68, 0
    v_mov_b32 v69, 0
    v_mov_b32 v70, 0
    v_mov_b32 v71, 0
    v_mov_b32 v72, 0
    v_mov_b32 v73, 0
    v_mov_b32 v74, 0
    v_mov_b32 v75, 0
    v_mov_b32 v76, 0
    v_mov_b32 v77, 0
    v_mov_b32 v78, 0
    v_mov_b32 v79, 0
    v_mov_b32 v80, 0
    v_mov_b32 v81, 0
    v_mov_b32 v82, 0
    v_mov_b32 v83, 0
    v_mov_b32 v84, 0
    v_mov_b32 v85, 0
    v_mov_b32 v86, 0
    v_mov_b32 v87, 0
    v_mov_b32 v88, 0
    v_mov_b32 v89, 0
    v_mov_b32 v90, 0
    v_mov_b32 v91, 0
    v_mov_b32 v92, 0
    v_mov_b32 v93, 0
    v_mov_b32 v94, 0
    v_mov_b32 v95, 0
    v_mov_b32 v96, 0
    v_mov_b32 v97, 0
    v_mov_b32 v98, 0
    v_mov_b32 v99, 0
    v_mov_b32 v100, 0
    v_mov_b32 v101, 0
    v_mov_b32 v102, 0
    v_mov_b32 v103, 0
    v_mov_b32 v104, 0
    v_mov_b32 v105, 0
    v_mov_b32 v106, 0
    v_mov_b32 v107, 0
    v_mov_b32 v108, 0
    v_mov_b32 v109, 0
    v_mov_b32 v110, 0
    v_mov_b32 v111, 0
    v_mov_b32 v112, 0
    v_mov_b32 v113, 0
    v_mov_b32 v114, 0
    v_mov_b32 v115, 0
    v_mov_b32 v116, 0
    v_mov_b32 v117, 0
    v_mov_b32 v118, 0
    v_mov_b32 v119, 0
    v_mov_b32 v120, 0
    v_mov_b32 v121, 0
    v_mov_b32 v122, 0
    v_mov_b32 v123, 0
    v_mov_b32 v124, 0
    v_mov_b32 v125, 0
    v_mov_b32 v126, 0
    v_mov_b32 v127, 0
    s_mov_b32 s40, 0
    buffer_load_dwordx4 v[128:131], v48, s[8:11], s40 offen
    buffer_load_dwordx4 v[132:135], v49, s[8:11], s40 offen
    buffer_load_dwordx4 v[136:139], v50, s[8:11], s40 offen
    buffer_load_dwordx4 v[140:143], v51, s[8:11], s40 offen
    buffer_load_dwordx4 v[144:147], v52, s[8:11], s40 offen
    buffer_load_dwordx4 v[148:151], v53, s[8:11], s40 offen
    buffer_load_dwordx4 v[152:155], v54, s[8:11], s40 offen
    buffer_load_dwordx4 v[156:159], v55, s[8:11], s40 offen
    s_waitcnt vmcnt(0)
    ds_write_b128 v58, v[128:131] offset:0
    ds_write_b128 v58, v[132:135] offset:4608
    ds_write_b128 v58, v[136:139] offset:9216
    ds_write_b128 v58, v[140:143] offset:13824
    ds_write_b128 v59, v[144:147] offset:0
    ds_write_b128 v59, v[148:151] offset:4608
    ds_write_b128 v59, v[152:155] offset:9216
    ds_write_b128 v59, v[156:159] offset:13824
    s_mov_b32 s40, 128
    buffer_load_dwordx4 v[128:131], v48, s[8:11], s40 offen
    buffer_load_dwordx4 v[132:135], v49, s[8:11], s40 offen
    buffer_load_dwordx4 v[136:139], v50, s[8:11], s40 offen
    buffer_load_dwordx4 v[140:143], v51, s[8:11], s40 offen
    buffer_load_dwordx4 v[144:147], v52, s[8:11], s40 offen
    buffer_load_dwordx4 v[148:151], v53, s[8:11], s40 offen
    buffer_load_dwordx4 v[152:155], v54, s[8:11], s40 offen
    buffer_load_dwordx4 v[156:159], v55, s[8:11], s40 offen
    s_waitcnt lgkmcnt(0)
    s_barrier
    s_mov_b32 s41, 0
Lg_v_loop:
    ds_read_b128 v[168:171], v56 offset:0
    ds_read_b128 v[172:175], v56 offset:4608
    ds_read_b128 v[176:179], v57 offset:0
    ds_read_b128 v[180:183], v57 offset:4608
    ds_read_b128 v[184:187], v56 offset:32
    ds_read_b128 v[188:191], v56 offset:4640
    ds_read_b128 v[192:195], v57 offset:32
    ds_read_b128 v[196:199], v57 offset:4640
    s_waitcnt lgkmcnt(4)
    v_mfma_f32_32x32x16_bf16 v[64:79], v[168:171], v[176:179], v[64:79]
    v_mfma_f32_32x32x16_bf16 v[80:95], v[168:171], v[180:183], v[80:95]
    v_mfma_f32_32x32x16_bf16 v[96:111], v[172:175], v[176:179], v[96:111]
    v_mfma_f32_32x32x16_bf16 v[112:127], v[172:175], v[180:183], v[112:127]
    ds_read_b128 v[168:171], v56 offset:64
    ds_read_b128 v[172:175], v56 offset:4672
    ds_read_b128 v[176:179], v57 offset:64
    ds_read_b128 v[180:183], v57 offset:4672
    s_waitcnt lgkmcnt(4)
    v_mfma_f32_32x32x16_bf16 v[64:79], v[184:187], v[192:195], v[64:79]
    v_mfma_f32_32x32x16_bf16 v[80:95], v[184:187], v[196:199], v[80:95]
    v_mfma_f32_32x32x16_bf16 v[96:111], v[188:191], v[192:195], v[96:111]
    v_mfma_f32_32x32x16_bf16 v[112:127], v[188:191], v[196:199], v[112:127]
    ds_read_b128 v[184:187], v56 offset:96
    ds_read_b128 v[188:191], v56 offset:4704
    ds_read_b128 v[192:195], v57 offset:96
    ds_read_b128 v[196:199], v57 offset:4704
    s_waitcnt lgkmcnt(4)
    v_mfma_f32_32x32x16_bf16 v[64:79], v[168:171], v[176:179], v[64:79]
    v_mfma_f32_32x32x16_bf16 v[80:95], v[168:171], v[180:183], v[80:95]
    v_mfma_f32_32x32x16_bf16 v[96:111], v[172:175], v[176:179], v[96:111]
    v_mfma_f32_32x32x16_bf16 v[112:127], v[172:175], v[180:183], v[112:127]
    s_waitcnt lgkmcnt(0)
    v_mfma_f32_32x32x16_bf16 v[64:79], v[184:187], v[192:195], v[64:79]
    v_mfma_f32_32x32x16_bf16 v[80:95], v[184:187], v[196:199], v[80:95]
    v_mfma_f32_32x32x16_bf16 v[96:111], v[188:191], v[192:195], v[96:111]
    v_mfma_f32_32x32x16_bf16 v[112:127], v[188:191], v[196:199], v[112:127]
    s_waitcnt vmcnt(0)
    ds_write_b128 v58, v[128:131] offset:36864
    ds_write_b128 v58, v[132:135] offset:41472
    ds_write_b128 v58, v[136:139] offset:46080
    ds_write_b128 v58, v[140:143] offset:50688
    ds_write_b128 v59, v[144:147] offset:36864
    ds_write_b128 v59, v[148:151] offset:41472
    ds_write_b128 v59, v[152:155] offset:46080
    ds_write_b128 v59, v[156:159] offset:50688
    s_add_u32 s40, s40, 128
    buffer_load_dwordx4 v[128:131], v48, s[8:11], s40 offen
    buffer_load_dwordx4 v[132:135], v49, s[8:11], s40 offen
    buffer_load_dwordx4 v[136:139], v50, s[8:11], s40 offen
    buffer_load_dwordx4 v[140:143], v51, s[8:11], s40 offen
    buffer_load_dwordx4 v[144:147], v52, s[8:11], s40 offen
    buffer_load_dwordx4 v[148:151], v53, s[8:11], s40 offen
    buffer_load_dwordx4 v[152:155], v54, s[8:11], s40 offen
    buffer_load_dwordx4 v[156:159], v55, s[8:11], s40 offen
    s_waitcnt lgkmcnt(0)
    s_barrier
    ds_read_b128 v[168:171], v56 offset:36864
    ds_read_b128 v[172:175], v56 offset:41472
    ds_read_b128 v[176:179], v57 offset:36864
    ds_read_b128 v[180:183], v57 offset:41472
    ds_read_b128 v[184:187], v56 offset:36896
    ds_read_b128 v[188:191], v56 offset:41504
    ds_read_b128 v[192:195], v57 offset:36896
    ds_read_b128 v[196:199], v57 offset:41504
    s_waitcnt lgkmcnt(4)
    v_mfma_f32_32x32x16_bf16 v[64:79], v[168:171], v[176:179], v[64:79]
    v_mfma_f32_32x32x16_bf16 v[80:95], v[168:171], v[180:183], v[80:95]
    v_mfma_f32_32x32x16_bf16 v[96:111], v[172:175], v[176:179], v[96:111]
    v_mfma_f32_32x32x16_bf16 v[112:127], v[172:175], v[180:183], v[112:127]
    ds_read_b128 v[168:171], v56 offset:36928
    ds_read_b128 v[172:175], v56 offset:41536
    ds_read_b128 v[176:179], v57 offset:36928
    ds_read_b128 v[180:183], v57 offset:41536
    s_waitcnt lgkmcnt(4)
    v_mfma_f32_32x32x16_bf16 v[64:79], v[184:187], v[192:195], v[64:79]
    v_mfma_f32_32x32x16_bf16 v[80:95], v[184:187], v[196:199], v[80:95]
    v_mfma_f32_32x32x16_bf16 v[96:111], v[188:191], v[192:195], v[96:111]
    v_mfma_f32_32x32x16_bf16 v[112:127], v[188:191], v[196:199], v[112:127]
    ds_read_b128 v[184:187], v56 offset:36960
    ds_read_b128 v[188:191], v56 offset:41568
    ds_read_b128 v[192:195], v57 offset:36960
    ds_read_b128 v[196:199], v57 offset:41568
    s_waitcnt lgkmcnt(4)
    v_mfma_f32_32x32x16_bf16 v[64:79], v[168:171], v[176:179], v[64:79]
    v_mfma_f32_32x32x16_bf16 v[80:95], v[168:171], v[180:183], v[80:95]
    v_mfma_f32_32x32x16_bf16 v[96:111], v[172:175], v[176:179], v[96:111]
    v_mfma_f32_32x32x16_bf16 v[112:127], v[172:175], v[180:183], v[112:127]
    s_waitcnt lgkmcnt(0)
    v_mfma_f32_32x32x16_bf16 v[64:79], v[184:187], v[192:195], v[64:79]
    v_mfma_f32_32x32x16_bf16 v[80:95], v[184:187], v[196:199], v[80:95]
    v_mfma_f32_32x32x16_bf16 v[96:111], v[188:191], v[192:195], v[96:111]
    v_mfma_f32_32x32x16_bf16 v[112:127], v[188:191], v[196:199], v[112:127]
    s_waitcnt vmcnt(0)
    ds_write_b128 v58, v[128:131] offset:0
    ds_write_b128 v58, v[132:135] offset:4608
    ds_write_b128 v58, v[136:139] offset:9216
    ds_write_b128 v58, v[140:143] offset:13824
    ds_write_b128 v59, v[144:147] offset:0
    ds_write_b128 v59, v[148:151] offset:4608
    ds_write_b128 v59, v[152:155] offset:9216
    ds_write_b128 v59, v[156:159] offset:13824
    s_add_u32 s40, s40, 128
    buffer_load_dwordx4 v[128:131], v48, s[8:11], s40 offen
    buffer_load_dwordx4 v[132:135], v49, s[8:11], s40 offen
    buffer_load_dwordx4 v[136:139], v50, s[8:11], s40 offen
    buffer_load_dwordx4 v[140:143], v51, s[8:11], s40 offen
    buffer_load_dwordx4 v[144:147], v52, s[8:11], s40 offen
    buffer_load_dwordx4 v[148:151], v53, s[8:11], s40 offen
    buffer_load_dwordx4 v[152:155], v54, s[8:11], s40 offen
    buffer_load_dwordx4 v[156:159], v55, s[8:11], s40 offen
    s_waitcnt lgkmcnt(0)
    s_barrier
    s_add_u32 s41, s41, 2
    s_cmp_lt_u32 s41, 10
    s_cbranch_scc1 Lg_v_loop
    s_waitcnt vmcnt(0)
    s_nop 15
    s_nop 15
    s_sub_u32 s39, s37, 12288
    v_add_u32 v10, s39, v9
    v_and_b32 v11, 1, v2
    v_lshlrev_b32 v11, 1, v11
    s_lshr_b32 s38, s36, 5
    v_add_u32 v11, s38, v11
    s_mov_b32 s38, 6144
    v_mul_lo_u32 v11, v11, s38
    v_add_u32 v10, v10, v11
    v_lshlrev_b32 v10, 6, v10
    v_lshl_add_u32 v10, v7, 3, v10
    v_add_u32 v10, 0x6000000, v10
    v_cvt_pk_bf16_f32 v12, v64, v65
    v_cvt_pk_bf16_f32 v13, v66, v67
    buffer_store_dwordx2 v[12:13], v10, s[8:11], 0 offen offset:0
    s_nop 0
    v_cvt_pk_bf16_f32 v12, v68, v69
    v_cvt_pk_bf16_f32 v13, v70, v71
    buffer_store_dwordx2 v[12:13], v10, s[8:11], 0 offen offset:16
    s_nop 0
    v_cvt_pk_bf16_f32 v12, v72, v73
    v_cvt_pk_bf16_f32 v13, v74, v75
    buffer_store_dwordx2 v[12:13], v10, s[8:11], 0 offen offset:32
    s_nop 0
    v_cvt_pk_bf16_f32 v12, v76, v77
    v_cvt_pk_bf16_f32 v13, v78, v79
    buffer_store_dwordx2 v[12:13], v10, s[8:11], 0 offen offset:48
    s_nop 0
    v_cvt_pk_bf16_f32 v12, v80, v81
    v_cvt_pk_bf16_f32 v13, v82, v83
    buffer_store_dwordx2 v[12:13], v10, s[8:11], 0 offen offset:2048
    s_nop 0
    v_cvt_pk_bf16_f32 v12, v84, v85
    v_cvt_pk_bf16_f32 v13, v86, v87
    buffer_store_dwordx2 v[12:13], v10, s[8:11], 0 offen offset:2064
    s_nop 0
    v_cvt_pk_bf16_f32 v12, v88, v89
    v_cvt_pk_bf16_f32 v13, v90, v91
    buffer_store_dwordx2 v[12:13], v10, s[8:11], 0 offen offset:2080
    s_nop 0
    v_cvt_pk_bf16_f32 v12, v92, v93
    v_cvt_pk_bf16_f32 v13, v94, v95
    buffer_store_dwordx2 v[12:13], v10, s[8:11], 0 offen offset:2096
    s_nop 0
    v_add_u32 v10, 393216, v10
    v_cvt_pk_bf16_f32 v12, v96, v97
    v_cvt_pk_bf16_f32 v13, v98, v99
    buffer_store_dwordx2 v[12:13], v10, s[8:11], 0 offen offset:0
    s_nop 0
    v_cvt_pk_bf16_f32 v12, v100, v101
    v_cvt_pk_bf16_f32 v13, v102, v103
    buffer_store_dwordx2 v[12:13], v10, s[8:11], 0 offen offset:16
    s_nop 0
    v_cvt_pk_bf16_f32 v12, v104, v105
    v_cvt_pk_bf16_f32 v13, v106, v107
    buffer_store_dwordx2 v[12:13], v10, s[8:11], 0 offen offset:32
    s_nop 0
    v_cvt_pk_bf16_f32 v12, v108, v109
    v_cvt_pk_bf16_f32 v13, v110, v111
    buffer_store_dwordx2 v[12:13], v10, s[8:11], 0 offen offset:48
    s_nop 0
    v_cvt_pk_bf16_f32 v12, v112, v113
    v_cvt_pk_bf16_f32 v13, v114, v115
    buffer_store_dwordx2 v[12:13], v10, s[8:11], 0 offen offset:2048
    s_nop 0
    v_cvt_pk_bf16_f32 v12, v116, v117
    v_cvt_pk_bf16_f32 v13, v118, v119
    buffer_store_dwordx2 v[12:13], v10, s[8:11], 0 offen offset:2064
    s_nop 0
    v_cvt_pk_bf16_f32 v12, v120, v121
    v_cvt_pk_bf16_f32 v13, v122, v123
    buffer_store_dwordx2 v[12:13], v10, s[8:11], 0 offen offset:2080
    s_nop 0
    v_cvt_pk_bf16_f32 v12, v124, v125
    v_cvt_pk_bf16_f32 v13, v126, v127
    buffer_store_dwordx2 v[12:13], v10, s[8:11], 0 offen offset:2096
    s_nop 0
Lqkv_end:
    s_endpgm
    .globl sequential_preLN__memory_aug_recurrent_mem_tr__mixer_channel_mlp__prompt_chain_kernel
    .p2align 8
    .type sequential_preLN__memory_aug_recurrent_mem_tr__mixer_channel_mlp__prompt_chain_kernel,@function
sequential_preLN__memory_aug_recurrent_mem_tr__mixer_channel_mlp__prompt_chain_kernel:
    s_cmp_ge_u32 s2, 256
    s_cbranch_scc1 Lch_end
    s_load_dwordx2 s[4:5], s[0:1], 112
    s_waitcnt lgkmcnt(0)
    s_mov_b32 s8, s4
    s_and_b32 s9, s5, 0xffff
    s_mov_b32 s10, 0x10000000
    s_mov_b32 s11, 0x00020000
    s_load_dwordx2 s[6:7], s[0:1], 8
    v_and_b32 v1, 63, v0
    v_lshrrev_b32 v2, 6, v0
    s_nop 0
    v_readfirstlane_b32 s14, v2
    s_lshr_b32 s12, s2, 3
    s_and_b32 s13, s2, 7
    v_and_b32 v3, 15, v1
    v_lshrrev_b32 v4, 4, v1
    s_lshl_b32 s16, s14, 4
    v_add_u32 v5, s16, v3
    v_mov_b32 v6, 0
    v_cmp_le_u32 vcc, 24, v5
    v_addc_co_u32 v6, vcc, 0, v6, vcc
    v_cmp_le_u32 vcc, 48, v5
    v_addc_co_u32 v6, vcc, 0, v6, vcc
    v_mul_u32_u24 v7, 24, v6
    v_sub_u32 v7, v5, v7
    s_mul_i32 s16, s13, 24
    v_add_u32 v7, s16, v7
    v_mul_u32_u24 v8, 6144, v6
    v_add_u32 v8, v8, v7
    s_mul_i32 s16, s12, 192
    v_add_u32 v8, s16, v8
    v_mul_u32_u24 v8, 1280, v8
    v_lshl_add_u32 v8, v4, 4, v8
    v_add_u32 v8, 0x400000, v8
    v_mov_b32 v9, 0xf0000000
    v_cmp_gt_u32 vcc, 72, v5
    s_nop 1
    v_cndmask_b32 v8, v9, v8, vcc
    buffer_load_dwordx4 v[100:103], v8, s[8:11], 0 offen offset:0
    buffer_load_dwordx4 v[104:107], v8, s[8:11], 0 offen offset:64
    buffer_load_dwordx4 v[108:111], v8, s[8:11], 0 offen offset:128
    buffer_load_dwordx4 v[112:115], v8, s[8:11], 0 offen offset:192
    buffer_load_dwordx4 v[116:119], v8, s[8:11], 0 offen offset:256
    buffer_load_dwordx4 v[120:123], v8, s[8:11], 0 offen offset:320
    buffer_load_dwordx4 v[124:127], v8, s[8:11], 0 offen offset:384
    buffer_load_dwordx4 v[128:131], v8, s[8:11], 0 offen offset:448
    buffer_load_dwordx4 v[132:135], v8, s[8:11], 0 offen offset:512
    buffer_load_dwordx4 v[136:139], v8, s[8:11], 0 offen offset:576
    buffer_load_dwordx4 v[140:143], v8, s[8:11], 0 offen offset:640
    buffer_load_dwordx4 v[144:147], v8, s[8:11], 0 offen offset:704
    buffer_load_dwordx4 v[148:151], v8, s[8:11], 0 offen offset:768
    buffer_load_dwordx4 v[152:155], v8, s[8:11], 0 offen offset:832
    buffer_load_dwordx4 v[156:159], v8, s[8:11], 0 offen offset:896
    buffer_load_dwordx4 v[160:163], v8, s[8:11], 0 offen offset:960
    buffer_load_dwordx4 v[164:167], v8, s[8:11], 0 offen offset:1024
    buffer_load_dwordx4 v[168:171], v8, s[8:11], 0 offen offset:1088
    buffer_load_dwordx4 v[172:175], v8, s[8:11], 0 offen offset:1152
    buffer_load_dwordx4 v[176:179], v8, s[8:11], 0 offen offset:1216
    s_mul_i32 s16, s13, 80
    s_lshl_b32 s17, s14, 4
    s_add_u32 s16, s16, s17
    v_add_u32 v9, s16, v3
    s_mov_b32 s17, 12288
    v_mul_lo_u32 v9, v9, s17
    s_mul_i32 s16, s12, 384
    v_add_u32 v9, s16, v9
    v_lshl_add_u32 v9, v4, 3, v9
    v_add_u32 v9, 0x1c00000, v9
    buffer_load_dwordx2 v[180:181], v9, s[8:11], 0 offen offset:0
    buffer_load_dwordx2 v[182:183], v9, s[8:11], 0 offen offset:32
    buffer_load_dwordx2 v[184:185], v9, s[8:11], 0 offen offset:64
    buffer_load_dwordx2 v[186:187], v9, s[8:11], 0 offen offset:96
    buffer_load_dwordx2 v[188:189], v9, s[8:11], 0 offen offset:128
    buffer_load_dwordx2 v[190:191], v9, s[8:11], 0 offen offset:160
    buffer_load_dwordx2 v[192:193], v9, s[8:11], 0 offen offset:192
    buffer_load_dwordx2 v[194:195], v9, s[8:11], 0 offen offset:224
    buffer_load_dwordx2 v[196:197], v9, s[8:11], 0 offen offset:256
    buffer_load_dwordx2 v[198:199], v9, s[8:11], 0 offen offset:288
    buffer_load_dwordx2 v[200:201], v9, s[8:11], 0 offen offset:320
    buffer_load_dwordx2 v[202:203], v9, s[8:11], 0 offen offset:352
    s_waitcnt lgkmcnt(0)
    s_mov_b32 s20, s6
    s_and_b32 s21, s7, 0xffff
    s_mov_b32 s22, 0x2800
    s_mov_b32 s23, 0x00020000
    v_add_u32 v10, 0, v0
    v_mul_u32_u24 v11, 0xcccd, v10
    v_lshrrev_b32 v11, 22, v11
    v_mul_u32_u24 v12, 80, v11
    v_sub_u32 v12, v10, v12
    v_lshlrev_b32 v13, 4, v10
    buffer_load_dwordx4 v[16:19], v13, s[20:23], 0 offen
    v_mul_u32_u24 v14, 1296, v11
    v_lshl_add_u32 v14, v12, 4, v14
    s_waitcnt vmcnt(0)
    ds_write_b128 v14, v[16:19] offset:0
    v_add_u32 v10, 320, v0
    v_mul_u32_u24 v11, 0xcccd, v10
    v_lshrrev_b32 v11, 22, v11
    v_mul_u32_u24 v12, 80, v11
    v_sub_u32 v12, v10, v12
    v_lshlrev_b32 v13, 4, v10
    buffer_load_dwordx4 v[16:19], v13, s[20:23], 0 offen
    v_mul_u32_u24 v14, 1296, v11
    v_lshl_add_u32 v14, v12, 4, v14
    s_waitcnt vmcnt(0)
    ds_write_b128 v14, v[16:19] offset:0
    s_mov_b32 s15, 0
    s_waitcnt vmcnt(0) lgkmcnt(0)
    s_lshl_b32 s16, s15, 5
    s_mul_i32 s18, s12, 384
    s_mov_b32 s17, 12288
    v_add_u32 v10, 0, v0
    v_mul_u32_u24 v11, 0xaaab, v10
    v_lshrrev_b32 v11, 20, v11
    v_mul_u32_u24 v12, 24, v11
    v_sub_u32 v12, v10, v12
    v_add_u32 v13, s16, v11
    v_mul_lo_u32 v13, v13, s17
    v_lshl_add_u32 v13, v12, 4, v13
    v_add_u32 v13, s18, v13
    v_add_u32 v13, 0x4800000, v13
    buffer_load_dwordx4 v[56:59], v13, s[8:11], 0 offen
    v_add_u32 v10, 320, v0
    v_mul_u32_u24 v11, 0xaaab, v10
    v_lshrrev_b32 v11, 20, v11
    v_mul_u32_u24 v12, 24, v11
    v_sub_u32 v12, v10, v12
    v_add_u32 v13, s16, v11
    v_mul_lo_u32 v13, v13, s17
    v_lshl_add_u32 v13, v12, 4, v13
    v_add_u32 v13, s18, v13
    v_add_u32 v13, 0x4800000, v13
    buffer_load_dwordx4 v[60:63], v13, s[8:11], 0 offen
    v_add_u32 v10, 640, v0
    v_mul_u32_u24 v11, 0xaaab, v10
    v_lshrrev_b32 v11, 20, v11
    v_mul_u32_u24 v12, 24, v11
    v_sub_u32 v12, v10, v12
    v_add_u32 v13, s16, v11
    v_mul_lo_u32 v13, v13, s17
    v_lshl_add_u32 v13, v12, 4, v13
    v_add_u32 v13, s18, v13
    v_add_u32 v13, 0x4800000, v13
    buffer_load_dwordx4 v[64:67], v13, s[8:11], 0 offen
    s_mul_i32 s19, s15, 6144
    s_mul_i32 s26, s12, 192
    s_add_u32 s19, s19, s26
    s_lshl_b32 s19, s19, 6
    v_add_u32 v10, 0, v0
    v_lshlrev_b32 v13, 4, v10
    v_add_u32 v13, s19, v13
    v_add_u32 v13, 0x6000000, v13
    buffer_load_dwordx4 v[68:71], v13, s[8:11], 0 offen
    v_add_u32 v10, 320, v0
    v_lshlrev_b32 v13, 4, v10
    v_add_u32 v13, s19, v13
    v_add_u32 v13, 0x6000000, v13
    buffer_load_dwordx4 v[72:75], v13, s[8:11], 0 offen
    v_add_u32 v10, 640, v0
    v_lshlrev_b32 v13, 4, v10
    v_add_u32 v13, s19, v13
    v_add_u32 v13, 0x6000000, v13
    buffer_load_dwordx4 v[76:79], v13, s[8:11], 0 offen
    s_waitcnt vmcnt(0)
    v_add_u32 v10, 0, v0
    v_cmp_gt_u32 vcc, 768, v10
    v_mul_u32_u24 v11, 0xaaab, v10
    v_lshrrev_b32 v11, 20, v11
    v_mul_u32_u24 v12, 24, v11
    v_sub_u32 v12, v10, v12
    v_mul_u32_u24 v14, 400, v11
    v_lshl_add_u32 v14, v12, 4, v14
    v_lshrrev_b32 v11, 2, v10
    v_and_b32 v12, 3, v10
    v_mul_u32_u24 v13, 72, v11
    v_lshl_add_u32 v13, v12, 4, v13
    s_and_saveexec_b64 s[24:25], vcc
    ds_write_b128 v14, v[56:59] offset:19840
    ds_write_b64 v13, v[68:69] offset:32640
    ds_write_b64 v13, v[70:71] offset:32648
    s_mov_b64 exec, s[24:25]
    v_add_u32 v10, 320, v0
    v_cmp_gt_u32 vcc, 768, v10
    v_mul_u32_u24 v11, 0xaaab, v10
    v_lshrrev_b32 v11, 20, v11
    v_mul_u32_u24 v12, 24, v11
    v_sub_u32 v12, v10, v12
    v_mul_u32_u24 v14, 400, v11
    v_lshl_add_u32 v14, v12, 4, v14
    v_lshrrev_b32 v11, 2, v10
    v_and_b32 v12, 3, v10
    v_mul_u32_u24 v13, 72, v11
    v_lshl_add_u32 v13, v12, 4, v13
    s_and_saveexec_b64 s[24:25], vcc
    ds_write_b128 v14, v[60:63] offset:19840
    ds_write_b64 v13, v[72:73] offset:32640
    ds_write_b64 v13, v[74:75] offset:32648
    s_mov_b64 exec, s[24:25]
    v_add_u32 v10, 640, v0
    v_cmp_gt_u32 vcc, 768, v10
    v_mul_u32_u24 v11, 0xaaab, v10
    v_lshrrev_b32 v11, 20, v11
    v_mul_u32_u24 v12, 24, v11
    v_sub_u32 v12, v10, v12
    v_mul_u32_u24 v14, 400, v11
    v_lshl_add_u32 v14, v12, 4, v14
    v_lshrrev_b32 v11, 2, v10
    v_and_b32 v12, 3, v10
    v_mul_u32_u24 v13, 72, v11
    v_lshl_add_u32 v13, v12, 4, v13
    s_and_saveexec_b64 s[24:25], vcc
    ds_write_b128 v14, v[64:67] offset:19840
    ds_write_b64 v13, v[76:77] offset:32640
    ds_write_b64 v13, v[78:79] offset:32648
    s_mov_b64 exec, s[24:25]
    s_waitcnt lgkmcnt(0)
    s_barrier
Lch_step:
Lch_body:
    v_and_b32 v10, 7, v3
    v_mul_u32_u24 v10, 1296, v10
    v_lshl_add_u32 v10, v4, 4, v10
    v_mov_b32 v20, 0
    v_mov_b32 v21, 0
    v_mov_b32 v22, 0
    v_mov_b32 v23, 0
    s_cmp_ge_u32 s14, 3
    s_cbranch_scc1 Lch_p1v
    ds_read_b128 v[36:39], v10 offset:0
    ds_read_b128 v[40:43], v10 offset:64
    ds_read_b128 v[44:47], v10 offset:128
    ds_read_b128 v[48:51], v10 offset:192
    ds_read_b128 v[52:55], v10 offset:256
    ds_read_b128 v[56:59], v10 offset:320
    ds_read_b128 v[60:63], v10 offset:384
    ds_read_b128 v[64:67], v10 offset:448
    ds_read_b128 v[68:71], v10 offset:512
    ds_read_b128 v[72:75], v10 offset:576
    s_waitcnt lgkmcnt(5)
    v_mfma_f32_16x16x32_bf16 v[20:23], v[100:103], v[36:39], v[20:23]
    v_mfma_f32_16x16x32_bf16 v[20:23], v[104:107], v[40:43], v[20:23]
    v_mfma_f32_16x16x32_bf16 v[20:23], v[108:111], v[44:47], v[20:23]
    v_mfma_f32_16x16x32_bf16 v[20:23], v[112:115], v[48:51], v[20:23]
    v_mfma_f32_16x16x32_bf16 v[20:23], v[116:119], v[52:55], v[20:23]
    ds_read_b128 v[36:39], v10 offset:640
    ds_read_b128 v[40:43], v10 offset:704
    ds_read_b128 v[44:47], v10 offset:768
    ds_read_b128 v[48:51], v10 offset:832
    ds_read_b128 v[52:55], v10 offset:896
    s_waitcnt lgkmcnt(5)
    v_mfma_f32_16x16x32_bf16 v[20:23], v[120:123], v[56:59], v[20:23]
    v_mfma_f32_16x16x32_bf16 v[20:23], v[124:127], v[60:63], v[20:23]
    v_mfma_f32_16x16x32_bf16 v[20:23], v[128:131], v[64:67], v[20:23]
    v_mfma_f32_16x16x32_bf16 v[20:23], v[132:135], v[68:71], v[20:23]
    v_mfma_f32_16x16x32_bf16 v[20:23], v[136:139], v[72:75], v[20:23]
    ds_read_b128 v[56:59], v10 offset:960
    ds_read_b128 v[60:63], v10 offset:1024
    ds_read_b128 v[64:67], v10 offset:1088
    ds_read_b128 v[68:71], v10 offset:1152
    ds_read_b128 v[72:75], v10 offset:1216
    s_waitcnt lgkmcnt(5)
    v_mfma_f32_16x16x32_bf16 v[20:23], v[140:143], v[36:39], v[20:23]
    v_mfma_f32_16x16x32_bf16 v[20:23], v[144:147], v[40:43], v[20:23]
    v_mfma_f32_16x16x32_bf16 v[20:23], v[148:151], v[44:47], v[20:23]
    v_mfma_f32_16x16x32_bf16 v[20:23], v[152:155], v[48:51], v[20:23]
    v_mfma_f32_16x16x32_bf16 v[20:23], v[156:159], v[52:55], v[20:23]
    s_waitcnt lgkmcnt(0)
    v_mfma_f32_16x16x32_bf16 v[20:23], v[160:163], v[56:59], v[20:23]
    v_mfma_f32_16x16x32_bf16 v[20:23], v[164:167], v[60:63], v[20:23]
    v_mfma_f32_16x16x32_bf16 v[20:23], v[168:171], v[64:67], v[20:23]
    v_mfma_f32_16x16x32_bf16 v[20:23], v[172:175], v[68:71], v[20:23]
    v_mfma_f32_16x16x32_bf16 v[20:23], v[176:179], v[72:75], v[20:23]
    s_branch Lch_p1d
Lch_p1v:
    ds_read_b128 v[36:39], v10 offset:0
    ds_read_b128 v[40:43], v10 offset:64
    ds_read_b128 v[44:47], v10 offset:128
    ds_read_b128 v[48:51], v10 offset:192
    ds_read_b128 v[52:55], v10 offset:256
    ds_read_b128 v[56:59], v10 offset:320
    ds_read_b128 v[60:63], v10 offset:384
    ds_read_b128 v[64:67], v10 offset:448
    ds_read_b128 v[68:71], v10 offset:512
    ds_read_b128 v[72:75], v10 offset:576
    s_waitcnt lgkmcnt(5)
    v_mfma_f32_16x16x32_bf16 v[20:23], v[36:39], v[100:103], v[20:23]
    v_mfma_f32_16x16x32_bf16 v[20:23], v[40:43], v[104:107], v[20:23]
    v_mfma_f32_16x16x32_bf16 v[20:23], v[44:47], v[108:111], v[20:23]
    v_mfma_f32_16x16x32_bf16 v[20:23], v[48:51], v[112:115], v[20:23]
    v_mfma_f32_16x16x32_bf16 v[20:23], v[52:55], v[116:119], v[20:23]
    ds_read_b128 v[36:39], v10 offset:640
    ds_read_b128 v[40:43], v10 offset:704
    ds_read_b128 v[44:47], v10 offset:768
    ds_read_b128 v[48:51], v10 offset:832
    ds_read_b128 v[52:55], v10 offset:896
    s_waitcnt lgkmcnt(5)
    v_mfma_f32_16x16x32_bf16 v[20:23], v[56:59], v[120:123], v[20:23]
    v_mfma_f32_16x16x32_bf16 v[20:23], v[60:63], v[124:127], v[20:23]
    v_mfma_f32_16x16x32_bf16 v[20:23], v[64:67], v[128:131], v[20:23]
    v_mfma_f32_16x16x32_bf16 v[20:23], v[68:71], v[132:135], v[20:23]
    v_mfma_f32_16x16x32_bf16 v[20:23], v[72:75], v[136:139], v[20:23]
    ds_read_b128 v[56:59], v10 offset:960
    ds_read_b128 v[60:63], v10 offset:1024
    ds_read_b128 v[64:67], v10 offset:1088
    ds_read_b128 v[68:71], v10 offset:1152
    ds_read_b128 v[72:75], v10 offset:1216
    s_waitcnt lgkmcnt(5)
    v_mfma_f32_16x16x32_bf16 v[20:23], v[36:39], v[140:143], v[20:23]
    v_mfma_f32_16x16x32_bf16 v[20:23], v[40:43], v[144:147], v[20:23]
    v_mfma_f32_16x16x32_bf16 v[20:23], v[44:47], v[148:151], v[20:23]
    v_mfma_f32_16x16x32_bf16 v[20:23], v[48:51], v[152:155], v[20:23]
    v_mfma_f32_16x16x32_bf16 v[20:23], v[52:55], v[156:159], v[20:23]
    s_waitcnt lgkmcnt(0)
    v_mfma_f32_16x16x32_bf16 v[20:23], v[56:59], v[160:163], v[20:23]
    v_mfma_f32_16x16x32_bf16 v[20:23], v[60:63], v[164:167], v[20:23]
    v_mfma_f32_16x16x32_bf16 v[20:23], v[64:67], v[168:171], v[20:23]
    v_mfma_f32_16x16x32_bf16 v[20:23], v[68:71], v[172:175], v[20:23]
    v_mfma_f32_16x16x32_bf16 v[20:23], v[72:75], v[176:179], v[20:23]
Lch_p1d:
    s_nop 15
    v_cvt_pk_bf16_f32 v24, v20, v21
    v_cvt_pk_bf16_f32 v25, v22, v23
    s_add_u32 s27, s15, 1
    v_mov_b32 v26, s27
    v_mov_b32 v27, 0
    s_and_b32 s28, s15, 1
    s_lshl_b32 s28, s28, 5
    s_add_u32 s28, s28, s12
    s_mul_i32 s28, s28, 18432
    s_add_u32 s28, s28, 0xb200000
    s_cmp_ge_u32 s14, 3
    s_cbranch_scc1 Lch_pubv
    s_lshl_b32 s16, s14, 4
    v_lshlrev_b32 v28, 2, v4
    v_add_u32 v28, s16, v28
    v_mov_b32 v29, 0
    v_cmp_le_u32 vcc, 24, v28
    v_addc_co_u32 v29, vcc, 0, v29, vcc
    v_mul_u32_u24 v30, 24, v29
    v_sub_u32 v30, v28, v30
    s_mul_i32 s16, s13, 24
    v_add_u32 v30, s16, v30
    v_mul_u32_u24 v31, 48, v3
    v_lshrrev_b32 v32, 2, v30
    v_add_u32 v31, v31, v32
    v_mul_u32_u24 v32, 384, v29
    v_add_u32 v31, v31, v32
    v_lshlrev_b32 v31, 4, v31
    v_add_u32 v31, s28, v31
    v_cmp_gt_u32 vcc, 8, v3
    s_and_saveexec_b64 s[24:25], vcc
    buffer_store_dwordx4 v[24:27], v31, s[8:11], 0 offen sc1
    v_cmp_eq_u32 vcc, 1, v29
    s_and_saveexec_b64 s[30:31], vcc
    s_lshl_b32 s16, s15, 3
    v_add_u32 v33, s16, v3
    v_mul_lo_u32 v33, v33, s17
    v_lshl_add_u32 v33, v30, 1, v33
    v_add_u32 v33, s18, v33
    v_add_u32 v33, 0x7800000, v33
    buffer_store_dwordx2 v[24:25], v33, s[8:11], 0 offen
    s_mov_b64 exec, s[24:25]
    s_branch Lch_pubd
Lch_pubv:
    s_sub_u32 s16, s14, 3
    s_lshl_b32 s16, s16, 4
    v_add_u32 v28, s16, v3
    s_mul_i32 s29, s13, 24
    v_add_u32 v30, s29, v28
    v_lshlrev_b32 v31, 1, v30
    v_add_u32 v31, v31, v4
    v_add_u32 v31, 768, v31
    v_lshlrev_b32 v31, 4, v31
    v_add_u32 v31, s28, v31
    v_cmp_gt_u32 vcc, 24, v28
    s_mov_b64 s[30:31], vcc
    v_cmp_gt_u32 vcc, 2, v4
    s_and_b64 vcc, vcc, s[30:31]
    s_and_saveexec_b64 s[24:25], vcc
    buffer_store_dwordx4 v[24:27], v31, s[8:11], 0 offen sc1
    s_mul_i32 s16, s15, 6144
    s_add_u32 s16, s16, s26
    v_add_u32 v33, s16, v30
    v_lshlrev_b32 v33, 4, v33
    v_lshl_add_u32 v33, v4, 3, v33
    v_add_u32 v33, 0x7e00000, v33
    buffer_store_dwordx2 v[24:25], v33, s[8:11], 0 offen
    s_mov_b64 exec, s[24:25]
Lch_pubd:
    s_cmp_ge_u32 s15, 63
    s_cbranch_scc1 Lch_end
    v_lshlrev_b32 v34, 4, v0
    v_add_u32 v34, s28, v34
Lch_gl:
    buffer_load_dwordx4 v[36:39], v34, s[8:11], 0 offen offset:0 sc1
    v_add_u32 v35, 5120, v34
    buffer_load_dwordx4 v[40:43], v35, s[8:11], 0 offen sc1
    v_add_u32 v35, 10240, v34
    buffer_load_dwordx4 v[44:47], v35, s[8:11], 0 offen sc1
    v_add_u32 v35, 15360, v34
    buffer_load_dwordx4 v[48:51], v35, s[8:11], 0 offen sc1
    s_waitcnt vmcnt(0)
    v_cmp_eq_u32 vcc, s27, v38
    v_cmp_eq_u32 s[30:31], s27, v42
    s_and_b64 vcc, vcc, s[30:31]
    v_cmp_eq_u32 s[30:31], s27, v46
    s_and_b64 vcc, vcc, s[30:31]
    v_cmp_eq_u32 s[30:31], s27, v50
    s_movk_i32 s34, 192
    v_cmp_gt_u32 s[32:33], s34, v0
    s_orn2_b64 s[30:31], s[30:31], s[32:33]
    s_and_b64 vcc, vcc, s[30:31]
    s_cmp_eq_u64 vcc, -1
    s_cbranch_scc1 Lch_gd
    s_sleep 6
    s_branch Lch_gl
Lch_gd:
    v_add_u32 v52, 0, v0
    v_cmp_gt_u32 vcc, 768, v52
    v_mul_u32_u24 v53, 0xaaab, v52
    v_lshrrev_b32 v53, 21, v53
    v_mul_u32_u24 v54, 48, v53
    v_sub_u32 v54, v52, v54
    v_mul_u32_u24 v55, 400, v53
    v_lshl_add_u32 v55, v54, 3, v55
    s_and_saveexec_b64 s[24:25], vcc
    ds_write_b64 v55, v[36:37] offset:10368
    s_mov_b64 exec, s[24:25]
    v_subrev_u32 v53, 768, v52
    v_cmp_gt_u32 vcc, 384, v53
    v_lshlrev_b32 v55, 3, v53
    s_and_saveexec_b64 s[24:25], vcc
    ds_write_b64 v55, v[36:37] offset:16768
    s_mov_b64 exec, s[24:25]
    v_add_u32 v52, 320, v0
    v_cmp_gt_u32 vcc, 768, v52
    v_mul_u32_u24 v53, 0xaaab, v52
    v_lshrrev_b32 v53, 21, v53
    v_mul_u32_u24 v54, 48, v53
    v_sub_u32 v54, v52, v54
    v_mul_u32_u24 v55, 400, v53
    v_lshl_add_u32 v55, v54, 3, v55
    s_and_saveexec_b64 s[24:25], vcc
    ds_write_b64 v55, v[40:41] offset:10368
    s_mov_b64 exec, s[24:25]
    v_subrev_u32 v53, 768, v52
    v_cmp_gt_u32 vcc, 384, v53
    v_lshlrev_b32 v55, 3, v53
    s_and_saveexec_b64 s[24:25], vcc
    ds_write_b64 v55, v[40:41] offset:16768
    s_mov_b64 exec, s[24:25]
    v_add_u32 v52, 640, v0
    v_cmp_gt_u32 vcc, 768, v52
    v_mul_u32_u24 v53, 0xaaab, v52
    v_lshrrev_b32 v53, 21, v53
    v_mul_u32_u24 v54, 48, v53
    v_sub_u32 v54, v52, v54
    v_mul_u32_u24 v55, 400, v53
    v_lshl_add_u32 v55, v54, 3, v55
    s_and_saveexec_b64 s[24:25], vcc
    ds_write_b64 v55, v[44:45] offset:10368
    s_mov_b64 exec, s[24:25]
    v_subrev_u32 v53, 768, v52
    v_cmp_gt_u32 vcc, 384, v53
    v_lshlrev_b32 v55, 3, v53
    s_and_saveexec_b64 s[24:25], vcc
    ds_write_b64 v55, v[44:45] offset:16768
    s_mov_b64 exec, s[24:25]
    v_add_u32 v52, 960, v0
    v_cmp_gt_u32 vcc, 768, v52
    v_mul_u32_u24 v53, 0xaaab, v52
    v_lshrrev_b32 v53, 21, v53
    v_mul_u32_u24 v54, 48, v53
    v_sub_u32 v54, v52, v54
    v_mul_u32_u24 v55, 400, v53
    v_lshl_add_u32 v55, v54, 3, v55
    s_and_saveexec_b64 s[24:25], vcc
    ds_write_b64 v55, v[48:49] offset:10368
    s_mov_b64 exec, s[24:25]
    v_subrev_u32 v53, 768, v52
    v_cmp_gt_u32 vcc, 384, v53
    v_lshlrev_b32 v55, 3, v53
    s_and_saveexec_b64 s[24:25], vcc
    ds_write_b64 v55, v[48:49] offset:16768
    s_mov_b64 exec, s[24:25]
    s_waitcnt lgkmcnt(0)
    s_barrier
    v_and_b32 v10, 7, v3
    v_mul_u32_u24 v10, 400, v10
    v_lshl_add_u32 v10, v4, 4, v10
    v_mul_u32_u24 v11, 400, v3
    v_lshl_add_u32 v11, v4, 4, v11
    v_mov_b32 v86, 0
    v_mov_b32 v87, 0
    v_mov_b32 v88, 0
    v_mov_b32 v89, 0
    v_mov_b32 v90, 0
    v_mov_b32 v91, 0
    v_mov_b32 v92, 0
    v_mov_b32 v93, 0
    v_mov_b32 v94, 0
    v_mov_b32 v95, 0
    v_mov_b32 v96, 0
    v_mov_b32 v97, 0
    ds_read_b128 v[28:31], v10 offset:10368
    ds_read_b128 v[32:35], v10 offset:13568
    ds_read_b128 v[36:39], v11 offset:19840
    ds_read_b128 v[40:43], v11 offset:26240
    ds_read_b128 v[44:47], v10 offset:10432
    ds_read_b128 v[48:51], v10 offset:13632
    ds_read_b128 v[52:55], v11 offset:19904
    ds_read_b128 v[56:59], v11 offset:26304
    ds_read_b128 v[60:63], v10 offset:10496
    ds_read_b128 v[64:67], v10 offset:13696
    ds_read_b128 v[68:71], v11 offset:19968
    ds_read_b128 v[72:75], v11 offset:26368
    s_waitcnt lgkmcnt(0)
    v_mfma_f32_16x16x32_bf16 v[86:89], v[32:35], v[28:31], v[86:89]
    v_mfma_f32_16x16x32_bf16 v[90:93], v[36:39], v[28:31], v[90:93]
    v_mfma_f32_16x16x32_bf16 v[94:97], v[40:43], v[28:31], v[94:97]
    v_mfma_f32_16x16x32_bf16 v[86:89], v[48:51], v[44:47], v[86:89]
    v_mfma_f32_16x16x32_bf16 v[90:93], v[52:55], v[44:47], v[90:93]
    v_mfma_f32_16x16x32_bf16 v[94:97], v[56:59], v[44:47], v[94:97]
    v_mfma_f32_16x16x32_bf16 v[86:89], v[64:67], v[60:63], v[86:89]
    v_mfma_f32_16x16x32_bf16 v[90:93], v[68:71], v[60:63], v[90:93]
    v_mfma_f32_16x16x32_bf16 v[94:97], v[72:75], v[60:63], v[94:97]
    ds_read_b128 v[28:31], v10 offset:10560
    ds_read_b128 v[32:35], v10 offset:13760
    ds_read_b128 v[36:39], v11 offset:20032
    ds_read_b128 v[40:43], v11 offset:26432
    ds_read_b128 v[44:47], v10 offset:10624
    ds_read_b128 v[48:51], v10 offset:13824
    ds_read_b128 v[52:55], v11 offset:20096
    ds_read_b128 v[56:59], v11 offset:26496
    ds_read_b128 v[60:63], v10 offset:10688
    ds_read_b128 v[64:67], v10 offset:13888
    ds_read_b128 v[68:71], v11 offset:20160
    ds_read_b128 v[72:75], v11 offset:26560
    s_waitcnt lgkmcnt(0)
    v_mfma_f32_16x16x32_bf16 v[86:89], v[32:35], v[28:31], v[86:89]
    v_mfma_f32_16x16x32_bf16 v[90:93], v[36:39], v[28:31], v[90:93]
    v_mfma_f32_16x16x32_bf16 v[94:97], v[40:43], v[28:31], v[94:97]
    v_mfma_f32_16x16x32_bf16 v[86:89], v[48:51], v[44:47], v[86:89]
    v_mfma_f32_16x16x32_bf16 v[90:93], v[52:55], v[44:47], v[90:93]
    v_mfma_f32_16x16x32_bf16 v[94:97], v[56:59], v[44:47], v[94:97]
    v_mfma_f32_16x16x32_bf16 v[86:89], v[64:67], v[60:63], v[86:89]
    v_mfma_f32_16x16x32_bf16 v[90:93], v[68:71], v[60:63], v[90:93]
    v_mfma_f32_16x16x32_bf16 v[94:97], v[72:75], v[60:63], v[94:97]
    s_nop 15
    v_cvt_pk_bf16_f32 v16, v86, v86
    v_lshlrev_b32 v86, 16, v16
    v_mul_f32 v86, 0x3d93cd3a, v86
    v_cvt_pk_bf16_f32 v16, v86, v86
    v_lshlrev_b32 v86, 16, v16
    v_cvt_pk_bf16_f32 v16, v87, v87
    v_lshlrev_b32 v87, 16, v16
    v_mul_f32 v87, 0x3d93cd3a, v87
    v_cvt_pk_bf16_f32 v16, v87, v87
    v_lshlrev_b32 v87, 16, v16
    v_cvt_pk_bf16_f32 v16, v88, v88
    v_lshlrev_b32 v88, 16, v16
    v_mul_f32 v88, 0x3d93cd3a, v88
    v_cvt_pk_bf16_f32 v16, v88, v88
    v_lshlrev_b32 v88, 16, v16
    v_cvt_pk_bf16_f32 v16, v89, v89
    v_lshlrev_b32 v89, 16, v16
    v_mul_f32 v89, 0x3d93cd3a, v89
    v_cvt_pk_bf16_f32 v16, v89, v89
    v_lshlrev_b32 v89, 16, v16
    v_cvt_pk_bf16_f32 v16, v90, v90
    v_lshlrev_b32 v90, 16, v16
    v_mul_f32 v90, 0x3d93cd3a, v90
    v_cvt_pk_bf16_f32 v16, v90, v90
    v_lshlrev_b32 v90, 16, v16
    v_cvt_pk_bf16_f32 v16, v91, v91
    v_lshlrev_b32 v91, 16, v16
    v_mul_f32 v91, 0x3d93cd3a, v91
    v_cvt_pk_bf16_f32 v16, v91, v91
    v_lshlrev_b32 v91, 16, v16
    v_cvt_pk_bf16_f32 v16, v92, v92
    v_lshlrev_b32 v92, 16, v16
    v_mul_f32 v92, 0x3d93cd3a, v92
    v_cvt_pk_bf16_f32 v16, v92, v92
    v_lshlrev_b32 v92, 16, v16
    v_cvt_pk_bf16_f32 v16, v93, v93
    v_lshlrev_b32 v93, 16, v16
    v_mul_f32 v93, 0x3d93cd3a, v93
    v_cvt_pk_bf16_f32 v16, v93, v93
    v_lshlrev_b32 v93, 16, v16
    v_cvt_pk_bf16_f32 v16, v94, v94
    v_lshlrev_b32 v94, 16, v16
    v_mul_f32 v94, 0x3d93cd3a, v94
    v_cvt_pk_bf16_f32 v16, v94, v94
    v_lshlrev_b32 v94, 16, v16
    v_cvt_pk_bf16_f32 v16, v95, v95
    v_lshlrev_b32 v95, 16, v16
    v_mul_f32 v95, 0x3d93cd3a, v95
    v_cvt_pk_bf16_f32 v16, v95, v95
    v_lshlrev_b32 v95, 16, v16
    v_cvt_pk_bf16_f32 v16, v96, v96
    v_lshlrev_b32 v96, 16, v16
    v_mul_f32 v96, 0x3d93cd3a, v96
    v_cvt_pk_bf16_f32 v16, v96, v96
    v_lshlrev_b32 v96, 16, v16
    v_cvt_pk_bf16_f32 v16, v97, v97
    v_lshlrev_b32 v97, 16, v16
    v_mul_f32 v97, 0x3d93cd3a, v97
    v_cvt_pk_bf16_f32 v16, v97, v97
    v_lshlrev_b32 v97, 16, v16
    v_lshlrev_b32 v15, 2, v4
    v_mov_b32 v17, 0xff7fffff
    v_add_u32 v16, 0, v15
    v_cmp_gt_u32 vcc, 8, v16
    s_nop 1
    v_cndmask_b32 v86, v17, v86, vcc
    v_add_u32 v16, 1, v15
    v_cmp_gt_u32 vcc, 8, v16
    s_nop 1
    v_cndmask_b32 v87, v17, v87, vcc
    v_add_u32 v16, 2, v15
    v_cmp_gt_u32 vcc, 8, v16
    s_nop 1
    v_cndmask_b32 v88, v17, v88, vcc
    v_add_u32 v16, 3, v15
    v_cmp_gt_u32 vcc, 8, v16
    s_nop 1
    v_cndmask_b32 v89, v17, v89, vcc
    v_mov_b32 v44, v86
    v_max_f32 v44, v44, v87
    v_max_f32 v44, v44, v88
    v_max_f32 v44, v44, v89
    v_max_f32 v44, v44, v90
    v_max_f32 v44, v44, v91
    v_max_f32 v44, v44, v92
    v_max_f32 v44, v44, v93
    v_max_f32 v44, v44, v94
    v_max_f32 v44, v44, v95
    v_max_f32 v44, v44, v96
    v_max_f32 v44, v44, v97
    v_xor_b32 v45, 16, v1
    v_lshlrev_b32 v45, 2, v45
    ds_bpermute_b32 v46, v45, v44
    s_waitcnt lgkmcnt(0)
    v_max_f32 v44, v44, v46
    v_xor_b32 v45, 32, v1
    v_lshlrev_b32 v45, 2, v45
    ds_bpermute_b32 v46, v45, v44
    s_waitcnt lgkmcnt(0)
    v_max_f32 v44, v44, v46
    v_mov_b32 v47, 0
    v_sub_f32 v86, v86, v44
    v_mul_f32 v86, 0x3fb8aa3b, v86
    v_exp_f32 v86, v86
    s_nop 0
    v_add_f32 v47, v47, v86
    v_sub_f32 v87, v87, v44
    v_mul_f32 v87, 0x3fb8aa3b, v87
    v_exp_f32 v87, v87
    s_nop 0
    v_add_f32 v47, v47, v87
    v_sub_f32 v88, v88, v44
    v_mul_f32 v88, 0x3fb8aa3b, v88
    v_exp_f32 v88, v88
    s_nop 0
    v_add_f32 v47, v47, v88
    v_sub_f32 v89, v89, v44
    v_mul_f32 v89, 0x3fb8aa3b, v89
    v_exp_f32 v89, v89
    s_nop 0
    v_add_f32 v47, v47, v89
    v_sub_f32 v90, v90, v44
    v_mul_f32 v90, 0x3fb8aa3b, v90
    v_exp_f32 v90, v90
    s_nop 0
    v_add_f32 v47, v47, v90
    v_sub_f32 v91, v91, v44
    v_mul_f32 v91, 0x3fb8aa3b, v91
    v_exp_f32 v91, v91
    s_nop 0
    v_add_f32 v47, v47, v91
    v_sub_f32 v92, v92, v44
    v_mul_f32 v92, 0x3fb8aa3b, v92
    v_exp_f32 v92, v92
    s_nop 0
    v_add_f32 v47, v47, v92
    v_sub_f32 v93, v93, v44
    v_mul_f32 v93, 0x3fb8aa3b, v93
    v_exp_f32 v93, v93
    s_nop 0
    v_add_f32 v47, v47, v93
    v_sub_f32 v94, v94, v44
    v_mul_f32 v94, 0x3fb8aa3b, v94
    v_exp_f32 v94, v94
    s_nop 0
    v_add_f32 v47, v47, v94
    v_sub_f32 v95, v95, v44
    v_mul_f32 v95, 0x3fb8aa3b, v95
    v_exp_f32 v95, v95
    s_nop 0
    v_add_f32 v47, v47, v95
    v_sub_f32 v96, v96, v44
    v_mul_f32 v96, 0x3fb8aa3b, v96
    v_exp_f32 v96, v96
    s_nop 0
    v_add_f32 v47, v47, v96
    v_sub_f32 v97, v97, v44
    v_mul_f32 v97, 0x3fb8aa3b, v97
    v_exp_f32 v97, v97
    s_nop 0
    v_add_f32 v47, v47, v97
    v_xor_b32 v45, 16, v1
    v_lshlrev_b32 v45, 2, v45
    ds_bpermute_b32 v46, v45, v47
    s_waitcnt lgkmcnt(0)
    v_add_f32 v47, v47, v46
    v_xor_b32 v45, 32, v1
    v_lshlrev_b32 v45, 2, v45
    ds_bpermute_b32 v46, v45, v47
    s_waitcnt lgkmcnt(0)
    v_add_f32 v47, v47, v46
    v_rcp_f32 v47, v47
    s_nop 0
    v_mul_f32 v86, v86, v47
    v_mul_f32 v87, v87, v47
    v_mul_f32 v88, v88, v47
    v_mul_f32 v89, v89, v47
    v_mul_f32 v90, v90, v47
    v_mul_f32 v91, v91, v47
    v_mul_f32 v92, v92, v47
    v_mul_f32 v93, v93, v47
    v_mul_f32 v94, v94, v47
    v_mul_f32 v95, v95, v47
    v_mul_f32 v96, v96, v47
    v_mul_f32 v97, v97, v47
    v_cvt_pk_bf16_f32 v76, v86, v87
    v_cvt_pk_bf16_f32 v77, v88, v89
    v_cvt_pk_bf16_f32 v78, v90, v91
    v_cvt_pk_bf16_f32 v79, v92, v93
    v_cvt_pk_bf16_f32 v80, v94, v95
    v_cvt_pk_bf16_f32 v81, v96, v97
    v_and_b32 v12, 1, v4
    v_lshlrev_b32 v12, 3, v12
    v_lshl_add_u32 v12, v3, 4, v12
    v_mul_u32_u24 v13, 72, v3
    v_lshl_add_u32 v13, v4, 3, v13
    v_mov_b32 v204, 0
    v_mov_b32 v205, 0
    v_mov_b32 v206, 0
    v_mov_b32 v207, 0
    v_mov_b32 v208, 0
    v_mov_b32 v209, 0
    v_mov_b32 v210, 0
    v_mov_b32 v211, 0
    v_mov_b32 v212, 0
    v_mov_b32 v213, 0
    v_mov_b32 v214, 0
    v_mov_b32 v215, 0
    v_mov_b32 v216, 0
    v_mov_b32 v217, 0
    v_mov_b32 v218, 0
    v_mov_b32 v219, 0
    v_mov_b32 v220, 0
    v_mov_b32 v221, 0
    v_mov_b32 v222, 0
    v_mov_b32 v223, 0
    v_mov_b32 v224, 0
    v_mov_b32 v225, 0
    v_mov_b32 v226, 0
    v_mov_b32 v227, 0
    v_mov_b32 v228, 0
    v_mov_b32 v229, 0
    v_mov_b32 v230, 0
    v_mov_b32 v231, 0
    v_mov_b32 v232, 0
    v_mov_b32 v233, 0
    v_mov_b32 v234, 0
    v_mov_b32 v235, 0
    v_mov_b32 v236, 0
    v_mov_b32 v237, 0
    v_mov_b32 v238, 0
    v_mov_b32 v239, 0
    v_mov_b32 v240, 0
    v_mov_b32 v241, 0
    v_mov_b32 v242, 0
    v_mov_b32 v243, 0
    v_mov_b32 v244, 0
    v_mov_b32 v245, 0
    v_mov_b32 v246, 0
    v_mov_b32 v247, 0
    v_mov_b32 v248, 0
    v_mov_b32 v249, 0
    v_mov_b32 v250, 0
    v_mov_b32 v251, 0
    ds_read_b64 v[28:29], v12 offset:16768
    ds_read_b64 v[30:31], v13 offset:32640
    ds_read_b64 v[32:33], v13 offset:32672
    ds_read_b64 v[34:35], v12 offset:17024
    ds_read_b64 v[36:37], v13 offset:33792
    ds_read_b64 v[38:39], v13 offset:33824
    ds_read_b64 v[40:41], v12 offset:17280
    ds_read_b64 v[42:43], v13 offset:34944
    ds_read_b64 v[44:45], v13 offset:34976
    ds_read_b64 v[46:47], v12 offset:17536
    ds_read_b64 v[48:49], v13 offset:36096
    ds_read_b64 v[50:51], v13 offset:36128
    ds_read_b64 v[52:53], v12 offset:17792
    ds_read_b64 v[54:55], v13 offset:37248
    ds_read_b64 v[56:57], v13 offset:37280
    ds_read_b64 v[58:59], v12 offset:18048
    ds_read_b64 v[60:61], v13 offset:38400
    ds_read_b64 v[62:63], v13 offset:38432
    s_waitcnt lgkmcnt(0)
    v_mfma_f32_16x16x16_bf16 v[204:207], v[28:29], v[76:77], v[204:207]
    v_mfma_f32_16x16x32_bf16 v[204:207], v[30:33], v[78:81], v[204:207]
    v_mfma_f32_16x16x16_bf16 v[208:211], v[34:35], v[76:77], v[208:211]
    v_mfma_f32_16x16x32_bf16 v[208:211], v[36:39], v[78:81], v[208:211]
    v_mfma_f32_16x16x16_bf16 v[212:215], v[40:41], v[76:77], v[212:215]
    v_mfma_f32_16x16x32_bf16 v[212:215], v[42:45], v[78:81], v[212:215]
    v_mfma_f32_16x16x16_bf16 v[216:219], v[46:47], v[76:77], v[216:219]
    v_mfma_f32_16x16x32_bf16 v[216:219], v[48:51], v[78:81], v[216:219]
    v_mfma_f32_16x16x16_bf16 v[220:223], v[52:53], v[76:77], v[220:223]
    v_mfma_f32_16x16x32_bf16 v[220:223], v[54:57], v[78:81], v[220:223]
    v_mfma_f32_16x16x16_bf16 v[224:227], v[58:59], v[76:77], v[224:227]
    v_mfma_f32_16x16x32_bf16 v[224:227], v[60:63], v[78:81], v[224:227]
    ds_read_b64 v[28:29], v12 offset:18304
    ds_read_b64 v[30:31], v13 offset:39552
    ds_read_b64 v[32:33], v13 offset:39584
    ds_read_b64 v[34:35], v12 offset:18560
    ds_read_b64 v[36:37], v13 offset:40704
    ds_read_b64 v[38:39], v13 offset:40736
    ds_read_b64 v[40:41], v12 offset:18816
    ds_read_b64 v[42:43], v13 offset:41856
    ds_read_b64 v[44:45], v13 offset:41888
    ds_read_b64 v[46:47], v12 offset:19072
    ds_read_b64 v[48:49], v13 offset:43008
    ds_read_b64 v[50:51], v13 offset:43040
    ds_read_b64 v[52:53], v12 offset:19328
    ds_read_b64 v[54:55], v13 offset:44160
    ds_read_b64 v[56:57], v13 offset:44192
    ds_read_b64 v[58:59], v12 offset:19584
    ds_read_b64 v[60:61], v13 offset:45312
    ds_read_b64 v[62:63], v13 offset:45344
    s_waitcnt lgkmcnt(0)
    v_mfma_f32_16x16x16_bf16 v[228:231], v[28:29], v[76:77], v[228:231]
    v_mfma_f32_16x16x32_bf16 v[228:231], v[30:33], v[78:81], v[228:231]
    v_mfma_f32_16x16x16_bf16 v[232:235], v[34:35], v[76:77], v[232:235]
    v_mfma_f32_16x16x32_bf16 v[232:235], v[36:39], v[78:81], v[232:235]
    v_mfma_f32_16x16x16_bf16 v[236:239], v[40:41], v[76:77], v[236:239]
    v_mfma_f32_16x16x32_bf16 v[236:239], v[42:45], v[78:81], v[236:239]
    v_mfma_f32_16x16x16_bf16 v[240:243], v[46:47], v[76:77], v[240:243]
    v_mfma_f32_16x16x32_bf16 v[240:243], v[48:51], v[78:81], v[240:243]
    v_mfma_f32_16x16x16_bf16 v[244:247], v[52:53], v[76:77], v[244:247]
    v_mfma_f32_16x16x32_bf16 v[244:247], v[54:57], v[78:81], v[244:247]
    v_mfma_f32_16x16x16_bf16 v[248:251], v[58:59], v[76:77], v[248:251]
    v_mfma_f32_16x16x32_bf16 v[248:251], v[60:63], v[78:81], v[248:251]
    s_nop 15
    v_mov_b32 v20, 0
    v_mov_b32 v21, 0
    v_mov_b32 v22, 0
    v_mov_b32 v23, 0
    v_cvt_pk_bf16_f32 v82, v204, v205
    v_cvt_pk_bf16_f32 v83, v206, v207
    v_cvt_pk_bf16_f32 v84, v208, v209
    v_cvt_pk_bf16_f32 v85, v210, v211
    s_nop 1
    v_mfma_f32_16x16x32_bf16 v[20:23], v[180:183], v[82:85], v[20:23]
    s_nop 7
    v_cvt_pk_bf16_f32 v82, v212, v213
    v_cvt_pk_bf16_f32 v83, v214, v215
    v_cvt_pk_bf16_f32 v84, v216, v217
    v_cvt_pk_bf16_f32 v85, v218, v219
    s_nop 1
    v_mfma_f32_16x16x32_bf16 v[20:23], v[184:187], v[82:85], v[20:23]
    s_nop 7
    v_cvt_pk_bf16_f32 v82, v220, v221
    v_cvt_pk_bf16_f32 v83, v222, v223
    v_cvt_pk_bf16_f32 v84, v224, v225
    v_cvt_pk_bf16_f32 v85, v226, v227
    s_nop 1
    v_mfma_f32_16x16x32_bf16 v[20:23], v[188:191], v[82:85], v[20:23]
    s_nop 7
    v_cvt_pk_bf16_f32 v82, v228, v229
    v_cvt_pk_bf16_f32 v83, v230, v231
    v_cvt_pk_bf16_f32 v84, v232, v233
    v_cvt_pk_bf16_f32 v85, v234, v235
    s_nop 1
    v_mfma_f32_16x16x32_bf16 v[20:23], v[192:195], v[82:85], v[20:23]
    s_nop 7
    v_cvt_pk_bf16_f32 v82, v236, v237
    v_cvt_pk_bf16_f32 v83, v238, v239
    v_cvt_pk_bf16_f32 v84, v240, v241
    v_cvt_pk_bf16_f32 v85, v242, v243
    s_nop 1
    v_mfma_f32_16x16x32_bf16 v[20:23], v[196:199], v[82:85], v[20:23]
    s_nop 7
    v_cvt_pk_bf16_f32 v82, v244, v245
    v_cvt_pk_bf16_f32 v83, v246, v247
    v_cvt_pk_bf16_f32 v84, v248, v249
    v_cvt_pk_bf16_f32 v85, v250, v251
    s_nop 1
    v_mfma_f32_16x16x32_bf16 v[20:23], v[200:203], v[82:85], v[20:23]
    s_nop 7
    s_nop 15
    s_mul_i32 s16, s27, 20480
    s_mul_i32 s29, s13, 80
    s_lshl_b32 s30, s14, 4
    s_add_u32 s29, s29, s30
    v_mul_u32_u24 v14, 640, v3
    v_lshl_add_u32 v14, v4, 2, v14
    v_add_u32 v14, s29, v14
    v_lshlrev_b32 v14, 2, v14
    v_add_u32 v14, s16, v14
    v_add_u32 v14, 0xb000000, v14
    v_cmp_gt_u32 vcc, 8, v3
    s_and_saveexec_b64 s[24:25], vcc
    buffer_atomic_add_f32 v20, v14, s[8:11], 0 offen offset:0
    buffer_atomic_add_f32 v21, v14, s[8:11], 0 offen offset:4
    buffer_atomic_add_f32 v22, v14, s[8:11], 0 offen offset:8
    buffer_atomic_add_f32 v23, v14, s[8:11], 0 offen offset:12
    s_mov_b64 exec, s[24:25]
    s_waitcnt vmcnt(0)
    s_barrier
    v_cmp_eq_u32 vcc, 0, v0
    s_and_saveexec_b64 s[24:25], vcc
    s_and_b32 s16, s2, 15
    s_lshl_b32 s16, s16, 7
    s_add_u32 s16, s16, 0xb400000
    v_mov_b32 v14, s16
    v_mov_b32 v15, 1
    buffer_atomic_add v15, v14, s[8:11], 0 offen
    s_mov_b64 exec, s[24:25]
    s_lshl_b32 s16, s27, 5
    s_mul_i32 s18, s12, 384
    s_mov_b32 s17, 12288
    v_add_u32 v10, 0, v0
    v_mul_u32_u24 v11, 0xaaab, v10
    v_lshrrev_b32 v11, 20, v11
    v_mul_u32_u24 v12, 24, v11
    v_sub_u32 v12, v10, v12
    v_add_u32 v13, s16, v11
    v_mul_lo_u32 v13, v13, s17
    v_lshl_add_u32 v13, v12, 4, v13
    v_add_u32 v13, s18, v13
    v_add_u32 v13, 0x4800000, v13
    buffer_load_dwordx4 v[56:59], v13, s[8:11], 0 offen
    v_add_u32 v10, 320, v0
    v_mul_u32_u24 v11, 0xaaab, v10
    v_lshrrev_b32 v11, 20, v11
    v_mul_u32_u24 v12, 24, v11
    v_sub_u32 v12, v10, v12
    v_add_u32 v13, s16, v11
    v_mul_lo_u32 v13, v13, s17
    v_lshl_add_u32 v13, v12, 4, v13
    v_add_u32 v13, s18, v13
    v_add_u32 v13, 0x4800000, v13
    buffer_load_dwordx4 v[60:63], v13, s[8:11], 0 offen
    v_add_u32 v10, 640, v0
    v_mul_u32_u24 v11, 0xaaab, v10
    v_lshrrev_b32 v11, 20, v11
    v_mul_u32_u24 v12, 24, v11
    v_sub_u32 v12, v10, v12
    v_add_u32 v13, s16, v11
    v_mul_lo_u32 v13, v13, s17
    v_lshl_add_u32 v13, v12, 4, v13
    v_add_u32 v13, s18, v13
    v_add_u32 v13, 0x4800000, v13
    buffer_load_dwordx4 v[64:67], v13, s[8:11], 0 offen
    s_mul_i32 s19, s27, 6144
    s_mul_i32 s26, s12, 192
    s_add_u32 s19, s19, s26
    s_lshl_b32 s19, s19, 6
    v_add_u32 v10, 0, v0
    v_lshlrev_b32 v13, 4, v10
    v_add_u32 v13, s19, v13
    v_add_u32 v13, 0x6000000, v13
    buffer_load_dwordx4 v[68:71], v13, s[8:11], 0 offen
    v_add_u32 v10, 320, v0
    v_lshlrev_b32 v13, 4, v10
    v_add_u32 v13, s19, v13
    v_add_u32 v13, 0x6000000, v13
    buffer_load_dwordx4 v[72:75], v13, s[8:11], 0 offen
    v_add_u32 v10, 640, v0
    v_lshlrev_b32 v13, 4, v10
    v_add_u32 v13, s19, v13
    v_add_u32 v13, 0x6000000, v13
    buffer_load_dwordx4 v[76:79], v13, s[8:11], 0 offen
    v_and_b32 v14, 15, v1
    v_lshlrev_b32 v14, 7, v14
    v_add_u32 v14, 0xb400000, v14
    s_lshl_b32 s29, s27, 4
    s_cmp_lg_u32 s14, 0
    s_cbranch_scc1 Lch_pd
Lch_pl:
    buffer_load_dword v15, v14, s[8:11], 0 offen sc1
    s_waitcnt vmcnt(0)
    v_cmp_le_u32 vcc, s29, v15
    s_cmp_eq_u64 vcc, -1
    s_cbranch_scc1 Lch_pd
    s_sleep 4
    s_branch Lch_pl
Lch_pd:
    s_barrier
    v_lshlrev_b32 v14, 6, v0
    s_mul_i32 s16, s27, 20480
    v_add_u32 v14, s16, v14
    v_add_u32 v14, 0xb000000, v14
    buffer_load_dwordx4 v[36:39], v14, s[8:11], 0 offen offset:0 sc1
    buffer_load_dwordx4 v[40:43], v14, s[8:11], 0 offen offset:16 sc1
    buffer_load_dwordx4 v[44:47], v14, s[8:11], 0 offen offset:32 sc1
    buffer_load_dwordx4 v[48:51], v14, s[8:11], 0 offen offset:48 sc1
    v_mul_u32_u24 v15, 0x667, v0
    v_lshrrev_b32 v15, 16, v15
    v_mul_u32_u24 v16, 40, v15
    v_sub_u32 v16, v0, v16
    v_mul_u32_u24 v15, 1296, v15
    v_lshl_add_u32 v15, v16, 5, v15
    s_waitcnt vmcnt(0)
    v_cvt_pk_bf16_f32 v24, v36, v37
    v_cvt_pk_bf16_f32 v25, v38, v39
    v_cvt_pk_bf16_f32 v26, v40, v41
    v_cvt_pk_bf16_f32 v27, v42, v43
    v_cvt_pk_bf16_f32 v28, v44, v45
    v_cvt_pk_bf16_f32 v29, v46, v47
    v_cvt_pk_bf16_f32 v30, v48, v49
    v_cvt_pk_bf16_f32 v31, v50, v51
    v_add_u32 v10, 0, v0
    v_cmp_gt_u32 vcc, 768, v10
    v_mul_u32_u24 v11, 0xaaab, v10
    v_lshrrev_b32 v11, 20, v11
    v_mul_u32_u24 v12, 24, v11
    v_sub_u32 v12, v10, v12
    v_mul_u32_u24 v14, 400, v11
    v_lshl_add_u32 v14, v12, 4, v14
    v_lshrrev_b32 v11, 2, v10
    v_and_b32 v12, 3, v10
    v_mul_u32_u24 v13, 72, v11
    v_lshl_add_u32 v13, v12, 4, v13
    s_and_saveexec_b64 s[24:25], vcc
    ds_write_b128 v14, v[56:59] offset:19840
    ds_write_b64 v13, v[68:69] offset:32640
    ds_write_b64 v13, v[70:71] offset:32648
    s_mov_b64 exec, s[24:25]
    v_add_u32 v10, 320, v0
    v_cmp_gt_u32 vcc, 768, v10
    v_mul_u32_u24 v11, 0xaaab, v10
    v_lshrrev_b32 v11, 20, v11
    v_mul_u32_u24 v12, 24, v11
    v_sub_u32 v12, v10, v12
    v_mul_u32_u24 v14, 400, v11
    v_lshl_add_u32 v14, v12, 4, v14
    v_lshrrev_b32 v11, 2, v10
    v_and_b32 v12, 3, v10
    v_mul_u32_u24 v13, 72, v11
    v_lshl_add_u32 v13, v12, 4, v13
    s_and_saveexec_b64 s[24:25], vcc
    ds_write_b128 v14, v[60:63] offset:19840
    ds_write_b64 v13, v[72:73] offset:32640
    ds_write_b64 v13, v[74:75] offset:32648
    s_mov_b64 exec, s[24:25]
    v_add_u32 v10, 640, v0
    v_cmp_gt_u32 vcc, 768, v10
    v_mul_u32_u24 v11, 0xaaab, v10
    v_lshrrev_b32 v11, 20, v11
    v_mul_u32_u24 v12, 24, v11
    v_sub_u32 v12, v10, v12
    v_mul_u32_u24 v14, 400, v11
    v_lshl_add_u32 v14, v12, 4, v14
    v_lshrrev_b32 v11, 2, v10
    v_and_b32 v12, 3, v10
    v_mul_u32_u24 v13, 72, v11
    v_lshl_add_u32 v13, v12, 4, v13
    s_and_saveexec_b64 s[24:25], vcc
    ds_write_b128 v14, v[64:67] offset:19840
    ds_write_b64 v13, v[76:77] offset:32640
    ds_write_b64 v13, v[78:79] offset:32648
    s_mov_b64 exec, s[24:25]
    ds_write_b128 v15, v[24:27] offset:0
    ds_write_b128 v15, v[28:31] offset:16
    s_waitcnt lgkmcnt(0)
    s_barrier
    s_add_u32 s15, s15, 1
    s_branch Lch_step
Lch_end:
    s_endpgm
    .globl sequential_preLN__memory_aug_recurrent_mem_tr__mixer_channel_mlp__prompt_attn_kernel
    .p2align 8
    .type sequential_preLN__memory_aug_recurrent_mem_tr__mixer_channel_mlp__prompt_attn_kernel,@function
sequential_preLN__memory_aug_recurrent_mem_tr__mixer_channel_mlp__prompt_attn_kernel:
    s_cmp_ge_u32 s2, 512
    s_cbranch_scc1 Lat_end
    s_load_dwordx2 s[4:5], s[0:1], 112
    s_waitcnt lgkmcnt(0)
    s_mov_b32 s8, s4
    s_and_b32 s9, s5, 0xffff
    s_mov_b32 s10, 0x10000000
    s_mov_b32 s11, 0x00020000
    v_and_b32 v1, 63, v0
    v_lshrrev_b32 v2, 6, v0
    s_nop 0
    v_readfirstlane_b32 s3, v2
    s_lshl_b32 s12, s2, 2
    s_add_u32 s12, s12, s3
    s_lshr_b32 s13, s12, 5
    s_and_b32 s14, s12, 31
    v_and_b32 v3, 15, v1
    v_lshrrev_b32 v4, 4, v1
    s_mul_i32 s15, s14, 384
    v_lshlrev_b32 v5, 4, v4
    v_add_u32 v5, s15, v5
    s_lshl_b32 s16, s13, 5
    v_add_u32 v6, s16, v3
    s_mov_b32 s17, 12288
    v_mul_lo_u32 v6, v6, s17
    v_add_u32 v6, v6, v5
    v_add_u32 v7, 0x3000000, v6
    v_add_u32 v8, 196608, v7
    buffer_load_dwordx4 v[100:103], v7, s[8:11], 0 offen offset:0
    buffer_load_dwordx4 v[104:107], v7, s[8:11], 0 offen offset:64
    buffer_load_dwordx4 v[108:111], v7, s[8:11], 0 offen offset:128
    buffer_load_dwordx4 v[112:115], v7, s[8:11], 0 offen offset:192
    buffer_load_dwordx4 v[116:119], v7, s[8:11], 0 offen offset:256
    buffer_load_dwordx4 v[120:123], v7, s[8:11], 0 offen offset:320
    buffer_load_dwordx4 v[124:127], v8, s[8:11], 0 offen offset:0
    buffer_load_dwordx4 v[128:131], v8, s[8:11], 0 offen offset:64
    buffer_load_dwordx4 v[132:135], v8, s[8:11], 0 offen offset:128
    buffer_load_dwordx4 v[136:139], v8, s[8:11], 0 offen offset:192
    buffer_load_dwordx4 v[140:143], v8, s[8:11], 0 offen offset:256
    buffer_load_dwordx4 v[144:147], v8, s[8:11], 0 offen offset:320
    v_add_u32 v9, 0x4800000, v6
    v_add_u32 v10, 196608, v9
    v_and_b32 v11, 7, v3
    s_lshl_b32 s18, s13, 3
    v_add_u32 v11, s18, v11
    v_mul_lo_u32 v11, v11, s17
    v_add_u32 v11, v11, v5
    v_add_u32 v11, 0x7800000, v11
    buffer_load_dwordx4 v[148:151], v11, s[8:11], 0 offen offset:0
    buffer_load_dwordx4 v[152:155], v11, s[8:11], 0 offen offset:64
    buffer_load_dwordx4 v[156:159], v11, s[8:11], 0 offen offset:128
    buffer_load_dwordx4 v[160:163], v11, s[8:11], 0 offen offset:192
    buffer_load_dwordx4 v[164:167], v11, s[8:11], 0 offen offset:256
    buffer_load_dwordx4 v[168:171], v11, s[8:11], 0 offen offset:320
    buffer_load_dwordx4 v[172:175], v9, s[8:11], 0 offen offset:0
    buffer_load_dwordx4 v[176:179], v9, s[8:11], 0 offen offset:64
    buffer_load_dwordx4 v[180:183], v9, s[8:11], 0 offen offset:128
    buffer_load_dwordx4 v[184:187], v9, s[8:11], 0 offen offset:192
    buffer_load_dwordx4 v[188:191], v9, s[8:11], 0 offen offset:256
    buffer_load_dwordx4 v[192:195], v9, s[8:11], 0 offen offset:320
    buffer_load_dwordx4 v[196:199], v10, s[8:11], 0 offen offset:0
    buffer_load_dwordx4 v[200:203], v10, s[8:11], 0 offen offset:64
    buffer_load_dwordx4 v[204:207], v10, s[8:11], 0 offen offset:128
    buffer_load_dwordx4 v[208:211], v10, s[8:11], 0 offen offset:192
    buffer_load_dwordx4 v[212:215], v10, s[8:11], 0 offen offset:256
    buffer_load_dwordx4 v[216:219], v10, s[8:11], 0 offen offset:320
    v_mov_b32 v20, 0
    v_mov_b32 v21, 0
    v_mov_b32 v22, 0
    v_mov_b32 v23, 0
    v_mov_b32 v24, 0
    v_mov_b32 v25, 0
    v_mov_b32 v26, 0
    v_mov_b32 v27, 0
    v_mov_b32 v28, 0
    v_mov_b32 v29, 0
    v_mov_b32 v30, 0
    v_mov_b32 v31, 0
    v_mov_b32 v32, 0
    v_mov_b32 v33, 0
    v_mov_b32 v34, 0
    v_mov_b32 v35, 0
    v_mov_b32 v36, 0
    v_mov_b32 v37, 0
    v_mov_b32 v38, 0
    v_mov_b32 v39, 0
    v_mov_b32 v40, 0
    v_mov_b32 v41, 0
    v_mov_b32 v42, 0
    v_mov_b32 v43, 0
    s_waitcnt vmcnt(0)
    v_mfma_f32_16x16x32_bf16 v[20:23], v[148:151], v[100:103], v[20:23]
    v_mfma_f32_16x16x32_bf16 v[20:23], v[152:155], v[104:107], v[20:23]
    v_mfma_f32_16x16x32_bf16 v[20:23], v[156:159], v[108:111], v[20:23]
    v_mfma_f32_16x16x32_bf16 v[20:23], v[160:163], v[112:115], v[20:23]
    v_mfma_f32_16x16x32_bf16 v[20:23], v[164:167], v[116:119], v[20:23]
    v_mfma_f32_16x16x32_bf16 v[20:23], v[168:171], v[120:123], v[20:23]
    v_mfma_f32_16x16x32_bf16 v[24:27], v[148:151], v[124:127], v[24:27]
    v_mfma_f32_16x16x32_bf16 v[24:27], v[152:155], v[128:131], v[24:27]
    v_mfma_f32_16x16x32_bf16 v[24:27], v[156:159], v[132:135], v[24:27]
    v_mfma_f32_16x16x32_bf16 v[24:27], v[160:163], v[136:139], v[24:27]
    v_mfma_f32_16x16x32_bf16 v[24:27], v[164:167], v[140:143], v[24:27]
    v_mfma_f32_16x16x32_bf16 v[24:27], v[168:171], v[144:147], v[24:27]
    v_mfma_f32_16x16x32_bf16 v[28:31], v[172:175], v[100:103], v[28:31]
    v_mfma_f32_16x16x32_bf16 v[28:31], v[176:179], v[104:107], v[28:31]
    v_mfma_f32_16x16x32_bf16 v[28:31], v[180:183], v[108:111], v[28:31]
    v_mfma_f32_16x16x32_bf16 v[28:31], v[184:187], v[112:115], v[28:31]
    v_mfma_f32_16x16x32_bf16 v[28:31], v[188:191], v[116:119], v[28:31]
    v_mfma_f32_16x16x32_bf16 v[28:31], v[192:195], v[120:123], v[28:31]
    v_mfma_f32_16x16x32_bf16 v[32:35], v[172:175], v[124:127], v[32:35]
    v_mfma_f32_16x16x32_bf16 v[32:35], v[176:179], v[128:131], v[32:35]
    v_mfma_f32_16x16x32_bf16 v[32:35], v[180:183], v[132:135], v[32:35]
    v_mfma_f32_16x16x32_bf16 v[32:35], v[184:187], v[136:139], v[32:35]
    v_mfma_f32_16x16x32_bf16 v[32:35], v[188:191], v[140:143], v[32:35]
    v_mfma_f32_16x16x32_bf16 v[32:35], v[192:195], v[144:147], v[32:35]
    v_mfma_f32_16x16x32_bf16 v[36:39], v[196:199], v[100:103], v[36:39]
    v_mfma_f32_16x16x32_bf16 v[36:39], v[200:203], v[104:107], v[36:39]
    v_mfma_f32_16x16x32_bf16 v[36:39], v[204:207], v[108:111], v[36:39]
    v_mfma_f32_16x16x32_bf16 v[36:39], v[208:211], v[112:115], v[36:39]
    v_mfma_f32_16x16x32_bf16 v[36:39], v[212:215], v[116:119], v[36:39]
    v_mfma_f32_16x16x32_bf16 v[36:39], v[216:219], v[120:123], v[36:39]
    v_mfma_f32_16x16x32_bf16 v[40:43], v[196:199], v[124:127], v[40:43]
    v_mfma_f32_16x16x32_bf16 v[40:43], v[200:203], v[128:131], v[40:43]
    v_mfma_f32_16x16x32_bf16 v[40:43], v[204:207], v[132:135], v[40:43]
    v_mfma_f32_16x16x32_bf16 v[40:43], v[208:211], v[136:139], v[40:43]
    v_mfma_f32_16x16x32_bf16 v[40:43], v[212:215], v[140:143], v[40:43]
    v_mfma_f32_16x16x32_bf16 v[40:43], v[216:219], v[144:147], v[40:43]
    s_nop 15
    s_mul_i32 s19, s13, 6144
    s_mul_i32 s20, s14, 192
    s_add_u32 s19, s19, s20
    v_add_u32 v12, s19, v3
    v_lshlrev_b32 v13, 6, v12
    v_lshl_add_u32 v13, v4, 3, v13
    v_add_u32 v13, 0x6000000, v13
    v_and_b32 v14, 1, v4
    v_lshlrev_b32 v12, 4, v12
    v_lshl_add_u32 v12, v14, 3, v12
    v_add_u32 v12, 0x7e00000, v12
    buffer_load_dwordx2 v[100:101], v13, s[8:11], 0 offen
    buffer_load_dwordx2 v[102:103], v13, s[8:11], 0 offen offset:32
    buffer_load_dwordx2 v[148:149], v12, s[8:11], 0 offen offset:0
    v_add_u32 v13, 1024, v13
    buffer_load_dwordx2 v[104:105], v13, s[8:11], 0 offen
    buffer_load_dwordx2 v[106:107], v13, s[8:11], 0 offen offset:32
    buffer_load_dwordx2 v[150:151], v12, s[8:11], 0 offen offset:256
    v_add_u32 v13, 1024, v13
    buffer_load_dwordx2 v[108:109], v13, s[8:11], 0 offen
    buffer_load_dwordx2 v[110:111], v13, s[8:11], 0 offen offset:32
    buffer_load_dwordx2 v[152:153], v12, s[8:11], 0 offen offset:512
    v_add_u32 v13, 1024, v13
    buffer_load_dwordx2 v[112:113], v13, s[8:11], 0 offen
    buffer_load_dwordx2 v[114:115], v13, s[8:11], 0 offen offset:32
    buffer_load_dwordx2 v[154:155], v12, s[8:11], 0 offen offset:768
    v_add_u32 v13, 1024, v13
    buffer_load_dwordx2 v[116:117], v13, s[8:11], 0 offen
    buffer_load_dwordx2 v[118:119], v13, s[8:11], 0 offen offset:32
    buffer_load_dwordx2 v[156:157], v12, s[8:11], 0 offen offset:1024
    v_add_u32 v13, 1024, v13
    buffer_load_dwordx2 v[120:121], v13, s[8:11], 0 offen
    buffer_load_dwordx2 v[122:123], v13, s[8:11], 0 offen offset:32
    buffer_load_dwordx2 v[158:159], v12, s[8:11], 0 offen offset:1280
    v_add_u32 v13, 1024, v13
    buffer_load_dwordx2 v[124:125], v13, s[8:11], 0 offen
    buffer_load_dwordx2 v[126:127], v13, s[8:11], 0 offen offset:32
    buffer_load_dwordx2 v[160:161], v12, s[8:11], 0 offen offset:1536
    v_add_u32 v13, 1024, v13
    buffer_load_dwordx2 v[128:129], v13, s[8:11], 0 offen
    buffer_load_dwordx2 v[130:131], v13, s[8:11], 0 offen offset:32
    buffer_load_dwordx2 v[162:163], v12, s[8:11], 0 offen offset:1792
    v_add_u32 v13, 1024, v13
    buffer_load_dwordx2 v[132:133], v13, s[8:11], 0 offen
    buffer_load_dwordx2 v[134:135], v13, s[8:11], 0 offen offset:32
    buffer_load_dwordx2 v[164:165], v12, s[8:11], 0 offen offset:2048
    v_add_u32 v13, 1024, v13
    buffer_load_dwordx2 v[136:137], v13, s[8:11], 0 offen
    buffer_load_dwordx2 v[138:139], v13, s[8:11], 0 offen offset:32
    buffer_load_dwordx2 v[166:167], v12, s[8:11], 0 offen offset:2304
    v_add_u32 v13, 1024, v13
    buffer_load_dwordx2 v[140:141], v13, s[8:11], 0 offen
    buffer_load_dwordx2 v[142:143], v13, s[8:11], 0 offen offset:32
    buffer_load_dwordx2 v[168:169], v12, s[8:11], 0 offen offset:2560
    v_add_u32 v13, 1024, v13
    buffer_load_dwordx2 v[144:145], v13, s[8:11], 0 offen
    buffer_load_dwordx2 v[146:147], v13, s[8:11], 0 offen offset:32
    buffer_load_dwordx2 v[170:171], v12, s[8:11], 0 offen offset:2816
    v_add_u32 v13, 1024, v13
    v_lshlrev_b32 v15, 2, v4
    v_cvt_pk_bf16_f32 v16, v20, v20
    v_lshlrev_b32 v20, 16, v16
    v_mul_f32 v20, 0x3d93cd3a, v20
    v_cvt_pk_bf16_f32 v16, v20, v20
    v_lshlrev_b32 v20, 16, v16
    v_cvt_pk_bf16_f32 v16, v21, v21
    v_lshlrev_b32 v21, 16, v16
    v_mul_f32 v21, 0x3d93cd3a, v21
    v_cvt_pk_bf16_f32 v16, v21, v21
    v_lshlrev_b32 v21, 16, v16
    v_cvt_pk_bf16_f32 v16, v22, v22
    v_lshlrev_b32 v22, 16, v16
    v_mul_f32 v22, 0x3d93cd3a, v22
    v_cvt_pk_bf16_f32 v16, v22, v22
    v_lshlrev_b32 v22, 16, v16
    v_cvt_pk_bf16_f32 v16, v23, v23
    v_lshlrev_b32 v23, 16, v16
    v_mul_f32 v23, 0x3d93cd3a, v23
    v_cvt_pk_bf16_f32 v16, v23, v23
    v_lshlrev_b32 v23, 16, v16
    v_cvt_pk_bf16_f32 v16, v28, v28
    v_lshlrev_b32 v28, 16, v16
    v_mul_f32 v28, 0x3d93cd3a, v28
    v_cvt_pk_bf16_f32 v16, v28, v28
    v_lshlrev_b32 v28, 16, v16
    v_cvt_pk_bf16_f32 v16, v29, v29
    v_lshlrev_b32 v29, 16, v16
    v_mul_f32 v29, 0x3d93cd3a, v29
    v_cvt_pk_bf16_f32 v16, v29, v29
    v_lshlrev_b32 v29, 16, v16
    v_cvt_pk_bf16_f32 v16, v30, v30
    v_lshlrev_b32 v30, 16, v16
    v_mul_f32 v30, 0x3d93cd3a, v30
    v_cvt_pk_bf16_f32 v16, v30, v30
    v_lshlrev_b32 v30, 16, v16
    v_cvt_pk_bf16_f32 v16, v31, v31
    v_lshlrev_b32 v31, 16, v16
    v_mul_f32 v31, 0x3d93cd3a, v31
    v_cvt_pk_bf16_f32 v16, v31, v31
    v_lshlrev_b32 v31, 16, v16
    v_cvt_pk_bf16_f32 v16, v36, v36
    v_lshlrev_b32 v36, 16, v16
    v_mul_f32 v36, 0x3d93cd3a, v36
    v_cvt_pk_bf16_f32 v16, v36, v36
    v_lshlrev_b32 v36, 16, v16
    v_cvt_pk_bf16_f32 v16, v37, v37
    v_lshlrev_b32 v37, 16, v16
    v_mul_f32 v37, 0x3d93cd3a, v37
    v_cvt_pk_bf16_f32 v16, v37, v37
    v_lshlrev_b32 v37, 16, v16
    v_cvt_pk_bf16_f32 v16, v38, v38
    v_lshlrev_b32 v38, 16, v16
    v_mul_f32 v38, 0x3d93cd3a, v38
    v_cvt_pk_bf16_f32 v16, v38, v38
    v_lshlrev_b32 v38, 16, v16
    v_cvt_pk_bf16_f32 v16, v39, v39
    v_lshlrev_b32 v39, 16, v16
    v_mul_f32 v39, 0x3d93cd3a, v39
    v_cvt_pk_bf16_f32 v16, v39, v39
    v_lshlrev_b32 v39, 16, v16
    v_add_u32 v16, 0, v15
    v_cmp_gt_u32 vcc, 8, v16
    v_mov_b32 v17, 0xff7fffff
    s_nop 1
    v_cndmask_b32 v20, v17, v20, vcc
    v_add_u32 v18, 0, v16
    v_add_u32 v19, 0, v3
    v_cmp_ge_u32 vcc, v19, v18
    s_nop 1
    v_cndmask_b32 v28, v17, v28, vcc
    v_add_u32 v18, 16, v16
    v_add_u32 v19, 0, v3
    v_cmp_ge_u32 vcc, v19, v18
    s_nop 1
    v_cndmask_b32 v36, v17, v36, vcc
    v_add_u32 v16, 1, v15
    v_cmp_gt_u32 vcc, 8, v16
    v_mov_b32 v17, 0xff7fffff
    s_nop 1
    v_cndmask_b32 v21, v17, v21, vcc
    v_add_u32 v18, 0, v16
    v_add_u32 v19, 0, v3
    v_cmp_ge_u32 vcc, v19, v18
    s_nop 1
    v_cndmask_b32 v29, v17, v29, vcc
    v_add_u32 v18, 16, v16
    v_add_u32 v19, 0, v3
    v_cmp_ge_u32 vcc, v19, v18
    s_nop 1
    v_cndmask_b32 v37, v17, v37, vcc
    v_add_u32 v16, 2, v15
    v_cmp_gt_u32 vcc, 8, v16
    v_mov_b32 v17, 0xff7fffff
    s_nop 1
    v_cndmask_b32 v22, v17, v22, vcc
    v_add_u32 v18, 0, v16
    v_add_u32 v19, 0, v3
    v_cmp_ge_u32 vcc, v19, v18
    s_nop 1
    v_cndmask_b32 v30, v17, v30, vcc
    v_add_u32 v18, 16, v16
    v_add_u32 v19, 0, v3
    v_cmp_ge_u32 vcc, v19, v18
    s_nop 1
    v_cndmask_b32 v38, v17, v38, vcc
    v_add_u32 v16, 3, v15
    v_cmp_gt_u32 vcc, 8, v16
    v_mov_b32 v17, 0xff7fffff
    s_nop 1
    v_cndmask_b32 v23, v17, v23, vcc
    v_add_u32 v18, 0, v16
    v_add_u32 v19, 0, v3
    v_cmp_ge_u32 vcc, v19, v18
    s_nop 1
    v_cndmask_b32 v31, v17, v31, vcc
    v_add_u32 v18, 16, v16
    v_add_u32 v19, 0, v3
    v_cmp_ge_u32 vcc, v19, v18
    s_nop 1
    v_cndmask_b32 v39, v17, v39, vcc
    v_mov_b32 v44, v20
    v_max_f32 v44, v44, v20
    v_max_f32 v44, v44, v21
    v_max_f32 v44, v44, v22
    v_max_f32 v44, v44, v23
    v_max_f32 v44, v44, v28
    v_max_f32 v44, v44, v29
    v_max_f32 v44, v44, v30
    v_max_f32 v44, v44, v31
    v_max_f32 v44, v44, v36
    v_max_f32 v44, v44, v37
    v_max_f32 v44, v44, v38
    v_max_f32 v44, v44, v39
    v_xor_b32 v45, 16, v1
    v_lshlrev_b32 v45, 2, v45
    ds_bpermute_b32 v46, v45, v44
    s_waitcnt lgkmcnt(0)
    v_max_f32 v44, v44, v46
    v_xor_b32 v45, 32, v1
    v_lshlrev_b32 v45, 2, v45
    ds_bpermute_b32 v46, v45, v44
    s_waitcnt lgkmcnt(0)
    v_max_f32 v44, v44, v46
    v_mov_b32 v47, 0
    v_sub_f32 v20, v20, v44
    v_mul_f32 v20, 0x3fb8aa3b, v20
    v_exp_f32 v20, v20
    s_nop 0
    v_add_f32 v47, v47, v20
    v_sub_f32 v21, v21, v44
    v_mul_f32 v21, 0x3fb8aa3b, v21
    v_exp_f32 v21, v21
    s_nop 0
    v_add_f32 v47, v47, v21
    v_sub_f32 v22, v22, v44
    v_mul_f32 v22, 0x3fb8aa3b, v22
    v_exp_f32 v22, v22
    s_nop 0
    v_add_f32 v47, v47, v22
    v_sub_f32 v23, v23, v44
    v_mul_f32 v23, 0x3fb8aa3b, v23
    v_exp_f32 v23, v23
    s_nop 0
    v_add_f32 v47, v47, v23
    v_sub_f32 v28, v28, v44
    v_mul_f32 v28, 0x3fb8aa3b, v28
    v_exp_f32 v28, v28
    s_nop 0
    v_add_f32 v47, v47, v28
    v_sub_f32 v29, v29, v44
    v_mul_f32 v29, 0x3fb8aa3b, v29
    v_exp_f32 v29, v29
    s_nop 0
    v_add_f32 v47, v47, v29
    v_sub_f32 v30, v30, v44
    v_mul_f32 v30, 0x3fb8aa3b, v30
    v_exp_f32 v30, v30
    s_nop 0
    v_add_f32 v47, v47, v30
    v_sub_f32 v31, v31, v44
    v_mul_f32 v31, 0x3fb8aa3b, v31
    v_exp_f32 v31, v31
    s_nop 0
    v_add_f32 v47, v47, v31
    v_sub_f32 v36, v36, v44
    v_mul_f32 v36, 0x3fb8aa3b, v36
    v_exp_f32 v36, v36
    s_nop 0
    v_add_f32 v47, v47, v36
    v_sub_f32 v37, v37, v44
    v_mul_f32 v37, 0x3fb8aa3b, v37
    v_exp_f32 v37, v37
    s_nop 0
    v_add_f32 v47, v47, v37
    v_sub_f32 v38, v38, v44
    v_mul_f32 v38, 0x3fb8aa3b, v38
    v_exp_f32 v38, v38
    s_nop 0
    v_add_f32 v47, v47, v38
    v_sub_f32 v39, v39, v44
    v_mul_f32 v39, 0x3fb8aa3b, v39
    v_exp_f32 v39, v39
    s_nop 0
    v_add_f32 v47, v47, v39
    v_xor_b32 v45, 16, v1
    v_lshlrev_b32 v45, 2, v45
    ds_bpermute_b32 v46, v45, v47
    s_waitcnt lgkmcnt(0)
    v_add_f32 v47, v47, v46
    v_xor_b32 v45, 32, v1
    v_lshlrev_b32 v45, 2, v45
    ds_bpermute_b32 v46, v45, v47
    s_waitcnt lgkmcnt(0)
    v_add_f32 v47, v47, v46
    v_rcp_f32 v47, v47
    s_nop 0
    v_mul_f32 v20, v20, v47
    v_mul_f32 v21, v21, v47
    v_mul_f32 v22, v22, v47
    v_mul_f32 v23, v23, v47
    v_cvt_pk_bf16_f32 v60, v20, v21
    v_cvt_pk_bf16_f32 v61, v22, v23
    v_mul_f32 v28, v28, v47
    v_mul_f32 v29, v29, v47
    v_mul_f32 v30, v30, v47
    v_mul_f32 v31, v31, v47
    v_cvt_pk_bf16_f32 v62, v28, v29
    v_cvt_pk_bf16_f32 v63, v30, v31
    v_mul_f32 v36, v36, v47
    v_mul_f32 v37, v37, v47
    v_mul_f32 v38, v38, v47
    v_mul_f32 v39, v39, v47
    v_cvt_pk_bf16_f32 v64, v36, v37
    v_cvt_pk_bf16_f32 v65, v38, v39
    v_cvt_pk_bf16_f32 v16, v24, v24
    v_lshlrev_b32 v24, 16, v16
    v_mul_f32 v24, 0x3d93cd3a, v24
    v_cvt_pk_bf16_f32 v16, v24, v24
    v_lshlrev_b32 v24, 16, v16
    v_cvt_pk_bf16_f32 v16, v25, v25
    v_lshlrev_b32 v25, 16, v16
    v_mul_f32 v25, 0x3d93cd3a, v25
    v_cvt_pk_bf16_f32 v16, v25, v25
    v_lshlrev_b32 v25, 16, v16
    v_cvt_pk_bf16_f32 v16, v26, v26
    v_lshlrev_b32 v26, 16, v16
    v_mul_f32 v26, 0x3d93cd3a, v26
    v_cvt_pk_bf16_f32 v16, v26, v26
    v_lshlrev_b32 v26, 16, v16
    v_cvt_pk_bf16_f32 v16, v27, v27
    v_lshlrev_b32 v27, 16, v16
    v_mul_f32 v27, 0x3d93cd3a, v27
    v_cvt_pk_bf16_f32 v16, v27, v27
    v_lshlrev_b32 v27, 16, v16
    v_cvt_pk_bf16_f32 v16, v32, v32
    v_lshlrev_b32 v32, 16, v16
    v_mul_f32 v32, 0x3d93cd3a, v32
    v_cvt_pk_bf16_f32 v16, v32, v32
    v_lshlrev_b32 v32, 16, v16
    v_cvt_pk_bf16_f32 v16, v33, v33
    v_lshlrev_b32 v33, 16, v16
    v_mul_f32 v33, 0x3d93cd3a, v33
    v_cvt_pk_bf16_f32 v16, v33, v33
    v_lshlrev_b32 v33, 16, v16
    v_cvt_pk_bf16_f32 v16, v34, v34
    v_lshlrev_b32 v34, 16, v16
    v_mul_f32 v34, 0x3d93cd3a, v34
    v_cvt_pk_bf16_f32 v16, v34, v34
    v_lshlrev_b32 v34, 16, v16
    v_cvt_pk_bf16_f32 v16, v35, v35
    v_lshlrev_b32 v35, 16, v16
    v_mul_f32 v35, 0x3d93cd3a, v35
    v_cvt_pk_bf16_f32 v16, v35, v35
    v_lshlrev_b32 v35, 16, v16
    v_cvt_pk_bf16_f32 v16, v40, v40
    v_lshlrev_b32 v40, 16, v16
    v_mul_f32 v40, 0x3d93cd3a, v40
    v_cvt_pk_bf16_f32 v16, v40, v40
    v_lshlrev_b32 v40, 16, v16
    v_cvt_pk_bf16_f32 v16, v41, v41
    v_lshlrev_b32 v41, 16, v16
    v_mul_f32 v41, 0x3d93cd3a, v41
    v_cvt_pk_bf16_f32 v16, v41, v41
    v_lshlrev_b32 v41, 16, v16
    v_cvt_pk_bf16_f32 v16, v42, v42
    v_lshlrev_b32 v42, 16, v16
    v_mul_f32 v42, 0x3d93cd3a, v42
    v_cvt_pk_bf16_f32 v16, v42, v42
    v_lshlrev_b32 v42, 16, v16
    v_cvt_pk_bf16_f32 v16, v43, v43
    v_lshlrev_b32 v43, 16, v16
    v_mul_f32 v43, 0x3d93cd3a, v43
    v_cvt_pk_bf16_f32 v16, v43, v43
    v_lshlrev_b32 v43, 16, v16
    v_add_u32 v16, 0, v15
    v_cmp_gt_u32 vcc, 8, v16
    v_mov_b32 v17, 0xff7fffff
    s_nop 1
    v_cndmask_b32 v24, v17, v24, vcc
    v_add_u32 v18, 0, v16
    v_add_u32 v19, 16, v3
    v_cmp_ge_u32 vcc, v19, v18
    s_nop 1
    v_cndmask_b32 v32, v17, v32, vcc
    v_add_u32 v18, 16, v16
    v_add_u32 v19, 16, v3
    v_cmp_ge_u32 vcc, v19, v18
    s_nop 1
    v_cndmask_b32 v40, v17, v40, vcc
    v_add_u32 v16, 1, v15
    v_cmp_gt_u32 vcc, 8, v16
    v_mov_b32 v17, 0xff7fffff
    s_nop 1
    v_cndmask_b32 v25, v17, v25, vcc
    v_add_u32 v18, 0, v16
    v_add_u32 v19, 16, v3
    v_cmp_ge_u32 vcc, v19, v18
    s_nop 1
    v_cndmask_b32 v33, v17, v33, vcc
    v_add_u32 v18, 16, v16
    v_add_u32 v19, 16, v3
    v_cmp_ge_u32 vcc, v19, v18
    s_nop 1
    v_cndmask_b32 v41, v17, v41, vcc
    v_add_u32 v16, 2, v15
    v_cmp_gt_u32 vcc, 8, v16
    v_mov_b32 v17, 0xff7fffff
    s_nop 1
    v_cndmask_b32 v26, v17, v26, vcc
    v_add_u32 v18, 0, v16
    v_add_u32 v19, 16, v3
    v_cmp_ge_u32 vcc, v19, v18
    s_nop 1
    v_cndmask_b32 v34, v17, v34, vcc
    v_add_u32 v18, 16, v16
    v_add_u32 v19, 16, v3
    v_cmp_ge_u32 vcc, v19, v18
    s_nop 1
    v_cndmask_b32 v42, v17, v42, vcc
    v_add_u32 v16, 3, v15
    v_cmp_gt_u32 vcc, 8, v16
    v_mov_b32 v17, 0xff7fffff
    s_nop 1
    v_cndmask_b32 v27, v17, v27, vcc
    v_add_u32 v18, 0, v16
    v_add_u32 v19, 16, v3
    v_cmp_ge_u32 vcc, v19, v18
    s_nop 1
    v_cndmask_b32 v35, v17, v35, vcc
    v_add_u32 v18, 16, v16
    v_add_u32 v19, 16, v3
    v_cmp_ge_u32 vcc, v19, v18
    s_nop 1
    v_cndmask_b32 v43, v17, v43, vcc
    v_mov_b32 v44, v24
    v_max_f32 v44, v44, v24
    v_max_f32 v44, v44, v25
    v_max_f32 v44, v44, v26
    v_max_f32 v44, v44, v27
    v_max_f32 v44, v44, v32
    v_max_f32 v44, v44, v33
    v_max_f32 v44, v44, v34
    v_max_f32 v44, v44, v35
    v_max_f32 v44, v44, v40
    v_max_f32 v44, v44, v41
    v_max_f32 v44, v44, v42
    v_max_f32 v44, v44, v43
    v_xor_b32 v45, 16, v1
    v_lshlrev_b32 v45, 2, v45
    ds_bpermute_b32 v46, v45, v44
    s_waitcnt lgkmcnt(0)
    v_max_f32 v44, v44, v46
    v_xor_b32 v45, 32, v1
    v_lshlrev_b32 v45, 2, v45
    ds_bpermute_b32 v46, v45, v44
    s_waitcnt lgkmcnt(0)
    v_max_f32 v44, v44, v46
    v_mov_b32 v47, 0
    v_sub_f32 v24, v24, v44
    v_mul_f32 v24, 0x3fb8aa3b, v24
    v_exp_f32 v24, v24
    s_nop 0
    v_add_f32 v47, v47, v24
    v_sub_f32 v25, v25, v44
    v_mul_f32 v25, 0x3fb8aa3b, v25
    v_exp_f32 v25, v25
    s_nop 0
    v_add_f32 v47, v47, v25
    v_sub_f32 v26, v26, v44
    v_mul_f32 v26, 0x3fb8aa3b, v26
    v_exp_f32 v26, v26
    s_nop 0
    v_add_f32 v47, v47, v26
    v_sub_f32 v27, v27, v44
    v_mul_f32 v27, 0x3fb8aa3b, v27
    v_exp_f32 v27, v27
    s_nop 0
    v_add_f32 v47, v47, v27
    v_sub_f32 v32, v32, v44
    v_mul_f32 v32, 0x3fb8aa3b, v32
    v_exp_f32 v32, v32
    s_nop 0
    v_add_f32 v47, v47, v32
    v_sub_f32 v33, v33, v44
    v_mul_f32 v33, 0x3fb8aa3b, v33
    v_exp_f32 v33, v33
    s_nop 0
    v_add_f32 v47, v47, v33
    v_sub_f32 v34, v34, v44
    v_mul_f32 v34, 0x3fb8aa3b, v34
    v_exp_f32 v34, v34
    s_nop 0
    v_add_f32 v47, v47, v34
    v_sub_f32 v35, v35, v44
    v_mul_f32 v35, 0x3fb8aa3b, v35
    v_exp_f32 v35, v35
    s_nop 0
    v_add_f32 v47, v47, v35
    v_sub_f32 v40, v40, v44
    v_mul_f32 v40, 0x3fb8aa3b, v40
    v_exp_f32 v40, v40
    s_nop 0
    v_add_f32 v47, v47, v40
    v_sub_f32 v41, v41, v44
    v_mul_f32 v41, 0x3fb8aa3b, v41
    v_exp_f32 v41, v41
    s_nop 0
    v_add_f32 v47, v47, v41
    v_sub_f32 v42, v42, v44
    v_mul_f32 v42, 0x3fb8aa3b, v42
    v_exp_f32 v42, v42
    s_nop 0
    v_add_f32 v47, v47, v42
    v_sub_f32 v43, v43, v44
    v_mul_f32 v43, 0x3fb8aa3b, v43
    v_exp_f32 v43, v43
    s_nop 0
    v_add_f32 v47, v47, v43
    v_xor_b32 v45, 16, v1
    v_lshlrev_b32 v45, 2, v45
    ds_bpermute_b32 v46, v45, v47
    s_waitcnt lgkmcnt(0)
    v_add_f32 v47, v47, v46
    v_xor_b32 v45, 32, v1
    v_lshlrev_b32 v45, 2, v45
    ds_bpermute_b32 v46, v45, v47
    s_waitcnt lgkmcnt(0)
    v_add_f32 v47, v47, v46
    v_rcp_f32 v47, v47
    s_nop 0
    v_mul_f32 v24, v24, v47
    v_mul_f32 v25, v25, v47
    v_mul_f32 v26, v26, v47
    v_mul_f32 v27, v27, v47
    v_cvt_pk_bf16_f32 v66, v24, v25
    v_cvt_pk_bf16_f32 v67, v26, v27
    v_mul_f32 v32, v32, v47
    v_mul_f32 v33, v33, v47
    v_mul_f32 v34, v34, v47
    v_mul_f32 v35, v35, v47
    v_cvt_pk_bf16_f32 v68, v32, v33
    v_cvt_pk_bf16_f32 v69, v34, v35
    v_mul_f32 v40, v40, v47
    v_mul_f32 v41, v41, v47
    v_mul_f32 v42, v42, v47
    v_mul_f32 v43, v43, v47
    v_cvt_pk_bf16_f32 v70, v40, v41
    v_cvt_pk_bf16_f32 v71, v42, v43
    s_waitcnt vmcnt(0)
    v_add_u32 v6, s16, v3
    v_mul_lo_u32 v6, v6, s17
    v_lshl_add_u32 v6, v4, 3, v6
    v_add_u32 v6, s15, v6
    v_add_u32 v6, 0x8400000, v6
    v_add_u32 v7, 196608, v6
    v_mov_b32 v80, 0
    v_mov_b32 v81, 0
    v_mov_b32 v82, 0
    v_mov_b32 v83, 0
    s_nop 1
    v_mfma_f32_16x16x16_bf16 v[80:83], v[148:149], v[60:61], v[80:83]
    v_mfma_f32_16x16x32_bf16 v[80:83], v[100:103], v[62:65], v[80:83]
    s_nop 15
    v_cvt_pk_bf16_f32 v84, v80, v81
    v_cvt_pk_bf16_f32 v85, v82, v83
    buffer_store_dwordx2 v[84:85], v6, s[8:11], 0 offen offset:0
    s_nop 0
    v_mov_b32 v80, 0
    v_mov_b32 v81, 0
    v_mov_b32 v82, 0
    v_mov_b32 v83, 0
    s_nop 1
    v_mfma_f32_16x16x16_bf16 v[80:83], v[148:149], v[66:67], v[80:83]
    v_mfma_f32_16x16x32_bf16 v[80:83], v[100:103], v[68:71], v[80:83]
    s_nop 15
    v_cvt_pk_bf16_f32 v84, v80, v81
    v_cvt_pk_bf16_f32 v85, v82, v83
    buffer_store_dwordx2 v[84:85], v7, s[8:11], 0 offen offset:0
    s_nop 0
    v_mov_b32 v80, 0
    v_mov_b32 v81, 0
    v_mov_b32 v82, 0
    v_mov_b32 v83, 0
    s_nop 1
    v_mfma_f32_16x16x16_bf16 v[80:83], v[150:151], v[60:61], v[80:83]
    v_mfma_f32_16x16x32_bf16 v[80:83], v[104:107], v[62:65], v[80:83]
    s_nop 15
    v_cvt_pk_bf16_f32 v84, v80, v81
    v_cvt_pk_bf16_f32 v85, v82, v83
    buffer_store_dwordx2 v[84:85], v6, s[8:11], 0 offen offset:32
    s_nop 0
    v_mov_b32 v80, 0
    v_mov_b32 v81, 0
    v_mov_b32 v82, 0
    v_mov_b32 v83, 0
    s_nop 1
    v_mfma_f32_16x16x16_bf16 v[80:83], v[150:151], v[66:67], v[80:83]
    v_mfma_f32_16x16x32_bf16 v[80:83], v[104:107], v[68:71], v[80:83]
    s_nop 15
    v_cvt_pk_bf16_f32 v84, v80, v81
    v_cvt_pk_bf16_f32 v85, v82, v83
    buffer_store_dwordx2 v[84:85], v7, s[8:11], 0 offen offset:32
    s_nop 0
    v_mov_b32 v80, 0
    v_mov_b32 v81, 0
    v_mov_b32 v82, 0
    v_mov_b32 v83, 0
    s_nop 1
    v_mfma_f32_16x16x16_bf16 v[80:83], v[152:153], v[60:61], v[80:83]
    v_mfma_f32_16x16x32_bf16 v[80:83], v[108:111], v[62:65], v[80:83]
    s_nop 15
    v_cvt_pk_bf16_f32 v84, v80, v81
    v_cvt_pk_bf16_f32 v85, v82, v83
    buffer_store_dwordx2 v[84:85], v6, s[8:11], 0 offen offset:64
    s_nop 0
    v_mov_b32 v80, 0
    v_mov_b32 v81, 0
    v_mov_b32 v82, 0
    v_mov_b32 v83, 0
    s_nop 1
    v_mfma_f32_16x16x16_bf16 v[80:83], v[152:153], v[66:67], v[80:83]
    v_mfma_f32_16x16x32_bf16 v[80:83], v[108:111], v[68:71], v[80:83]
    s_nop 15
    v_cvt_pk_bf16_f32 v84, v80, v81
    v_cvt_pk_bf16_f32 v85, v82, v83
    buffer_store_dwordx2 v[84:85], v7, s[8:11], 0 offen offset:64
    s_nop 0
    v_mov_b32 v80, 0
    v_mov_b32 v81, 0
    v_mov_b32 v82, 0
    v_mov_b32 v83, 0
    s_nop 1
    v_mfma_f32_16x16x16_bf16 v[80:83], v[154:155], v[60:61], v[80:83]
    v_mfma_f32_16x16x32_bf16 v[80:83], v[112:115], v[62:65], v[80:83]
    s_nop 15
    v_cvt_pk_bf16_f32 v84, v80, v81
    v_cvt_pk_bf16_f32 v85, v82, v83
    buffer_store_dwordx2 v[84:85], v6, s[8:11], 0 offen offset:96
    s_nop 0
    v_mov_b32 v80, 0
    v_mov_b32 v81, 0
    v_mov_b32 v82, 0
    v_mov_b32 v83, 0
    s_nop 1
    v_mfma_f32_16x16x16_bf16 v[80:83], v[154:155], v[66:67], v[80:83]
    v_mfma_f32_16x16x32_bf16 v[80:83], v[112:115], v[68:71], v[80:83]
    s_nop 15
    v_cvt_pk_bf16_f32 v84, v80, v81
    v_cvt_pk_bf16_f32 v85, v82, v83
    buffer_store_dwordx2 v[84:85], v7, s[8:11], 0 offen offset:96
    s_nop 0
    v_mov_b32 v80, 0
    v_mov_b32 v81, 0
    v_mov_b32 v82, 0
    v_mov_b32 v83, 0
    s_nop 1
    v_mfma_f32_16x16x16_bf16 v[80:83], v[156:157], v[60:61], v[80:83]
    v_mfma_f32_16x16x32_bf16 v[80:83], v[116:119], v[62:65], v[80:83]
    s_nop 15
    v_cvt_pk_bf16_f32 v84, v80, v81
    v_cvt_pk_bf16_f32 v85, v82, v83
    buffer_store_dwordx2 v[84:85], v6, s[8:11], 0 offen offset:128
    s_nop 0
    v_mov_b32 v80, 0
    v_mov_b32 v81, 0
    v_mov_b32 v82, 0
    v_mov_b32 v83, 0
    s_nop 1
    v_mfma_f32_16x16x16_bf16 v[80:83], v[156:157], v[66:67], v[80:83]
    v_mfma_f32_16x16x32_bf16 v[80:83], v[116:119], v[68:71], v[80:83]
    s_nop 15
    v_cvt_pk_bf16_f32 v84, v80, v81
    v_cvt_pk_bf16_f32 v85, v82, v83
    buffer_store_dwordx2 v[84:85], v7, s[8:11], 0 offen offset:128
    s_nop 0
    v_mov_b32 v80, 0
    v_mov_b32 v81, 0
    v_mov_b32 v82, 0
    v_mov_b32 v83, 0
    s_nop 1
    v_mfma_f32_16x16x16_bf16 v[80:83], v[158:159], v[60:61], v[80:83]
    v_mfma_f32_16x16x32_bf16 v[80:83], v[120:123], v[62:65], v[80:83]
    s_nop 15
    v_cvt_pk_bf16_f32 v84, v80, v81
    v_cvt_pk_bf16_f32 v85, v82, v83
    buffer_store_dwordx2 v[84:85], v6, s[8:11], 0 offen offset:160
    s_nop 0
    v_mov_b32 v80, 0
    v_mov_b32 v81, 0
    v_mov_b32 v82, 0
    v_mov_b32 v83, 0
    s_nop 1
    v_mfma_f32_16x16x16_bf16 v[80:83], v[158:159], v[66:67], v[80:83]
    v_mfma_f32_16x16x32_bf16 v[80:83], v[120:123], v[68:71], v[80:83]
    s_nop 15
    v_cvt_pk_bf16_f32 v84, v80, v81
    v_cvt_pk_bf16_f32 v85, v82, v83
    buffer_store_dwordx2 v[84:85], v7, s[8:11], 0 offen offset:160
    s_nop 0
    v_mov_b32 v80, 0
    v_mov_b32 v81, 0
    v_mov_b32 v82, 0
    v_mov_b32 v83, 0
    s_nop 1
    v_mfma_f32_16x16x16_bf16 v[80:83], v[160:161], v[60:61], v[80:83]
    v_mfma_f32_16x16x32_bf16 v[80:83], v[124:127], v[62:65], v[80:83]
    s_nop 15
    v_cvt_pk_bf16_f32 v84, v80, v81
    v_cvt_pk_bf16_f32 v85, v82, v83
    buffer_store_dwordx2 v[84:85], v6, s[8:11], 0 offen offset:192
    s_nop 0
    v_mov_b32 v80, 0
    v_mov_b32 v81, 0
    v_mov_b32 v82, 0
    v_mov_b32 v83, 0
    s_nop 1
    v_mfma_f32_16x16x16_bf16 v[80:83], v[160:161], v[66:67], v[80:83]
    v_mfma_f32_16x16x32_bf16 v[80:83], v[124:127], v[68:71], v[80:83]
    s_nop 15
    v_cvt_pk_bf16_f32 v84, v80, v81
    v_cvt_pk_bf16_f32 v85, v82, v83
    buffer_store_dwordx2 v[84:85], v7, s[8:11], 0 offen offset:192
    s_nop 0
    v_mov_b32 v80, 0
    v_mov_b32 v81, 0
    v_mov_b32 v82, 0
    v_mov_b32 v83, 0
    s_nop 1
    v_mfma_f32_16x16x16_bf16 v[80:83], v[162:163], v[60:61], v[80:83]
    v_mfma_f32_16x16x32_bf16 v[80:83], v[128:131], v[62:65], v[80:83]
    s_nop 15
    v_cvt_pk_bf16_f32 v84, v80, v81
    v_cvt_pk_bf16_f32 v85, v82, v83
    buffer_store_dwordx2 v[84:85], v6, s[8:11], 0 offen offset:224
    s_nop 0
    v_mov_b32 v80, 0
    v_mov_b32 v81, 0
    v_mov_b32 v82, 0
    v_mov_b32 v83, 0
    s_nop 1
    v_mfma_f32_16x16x16_bf16 v[80:83], v[162:163], v[66:67], v[80:83]
    v_mfma_f32_16x16x32_bf16 v[80:83], v[128:131], v[68:71], v[80:83]
    s_nop 15
    v_cvt_pk_bf16_f32 v84, v80, v81
    v_cvt_pk_bf16_f32 v85, v82, v83
    buffer_store_dwordx2 v[84:85], v7, s[8:11], 0 offen offset:224
    s_nop 0
    v_mov_b32 v80, 0
    v_mov_b32 v81, 0
    v_mov_b32 v82, 0
    v_mov_b32 v83, 0
    s_nop 1
    v_mfma_f32_16x16x16_bf16 v[80:83], v[164:165], v[60:61], v[80:83]
    v_mfma_f32_16x16x32_bf16 v[80:83], v[132:135], v[62:65], v[80:83]
    s_nop 15
    v_cvt_pk_bf16_f32 v84, v80, v81
    v_cvt_pk_bf16_f32 v85, v82, v83
    buffer_store_dwordx2 v[84:85], v6, s[8:11], 0 offen offset:256
    s_nop 0
    v_mov_b32 v80, 0
    v_mov_b32 v81, 0
    v_mov_b32 v82, 0
    v_mov_b32 v83, 0
    s_nop 1
    v_mfma_f32_16x16x16_bf16 v[80:83], v[164:165], v[66:67], v[80:83]
    v_mfma_f32_16x16x32_bf16 v[80:83], v[132:135], v[68:71], v[80:83]
    s_nop 15
    v_cvt_pk_bf16_f32 v84, v80, v81
    v_cvt_pk_bf16_f32 v85, v82, v83
    buffer_store_dwordx2 v[84:85], v7, s[8:11], 0 offen offset:256
    s_nop 0
    v_mov_b32 v80, 0
    v_mov_b32 v81, 0
    v_mov_b32 v82, 0
    v_mov_b32 v83, 0
    s_nop 1
    v_mfma_f32_16x16x16_bf16 v[80:83], v[166:167], v[60:61], v[80:83]
    v_mfma_f32_16x16x32_bf16 v[80:83], v[136:139], v[62:65], v[80:83]
    s_nop 15
    v_cvt_pk_bf16_f32 v84, v80, v81
    v_cvt_pk_bf16_f32 v85, v82, v83
    buffer_store_dwordx2 v[84:85], v6, s[8:11], 0 offen offset:288
    s_nop 0
    v_mov_b32 v80, 0
    v_mov_b32 v81, 0
    v_mov_b32 v82, 0
    v_mov_b32 v83, 0
    s_nop 1
    v_mfma_f32_16x16x16_bf16 v[80:83], v[166:167], v[66:67], v[80:83]
    v_mfma_f32_16x16x32_bf16 v[80:83], v[136:139], v[68:71], v[80:83]
    s_nop 15
    v_cvt_pk_bf16_f32 v84, v80, v81
    v_cvt_pk_bf16_f32 v85, v82, v83
    buffer_store_dwordx2 v[84:85], v7, s[8:11], 0 offen offset:288
    s_nop 0
    v_mov_b32 v80, 0
    v_mov_b32 v81, 0
    v_mov_b32 v82, 0
    v_mov_b32 v83, 0
    s_nop 1
    v_mfma_f32_16x16x16_bf16 v[80:83], v[168:169], v[60:61], v[80:83]
    v_mfma_f32_16x16x32_bf16 v[80:83], v[140:143], v[62:65], v[80:83]
    s_nop 15
    v_cvt_pk_bf16_f32 v84, v80, v81
    v_cvt_pk_bf16_f32 v85, v82, v83
    buffer_store_dwordx2 v[84:85], v6, s[8:11], 0 offen offset:320
    s_nop 0
    v_mov_b32 v80, 0
    v_mov_b32 v81, 0
    v_mov_b32 v82, 0
    v_mov_b32 v83, 0
    s_nop 1
    v_mfma_f32_16x16x16_bf16 v[80:83], v[168:169], v[66:67], v[80:83]
    v_mfma_f32_16x16x32_bf16 v[80:83], v[140:143], v[68:71], v[80:83]
    s_nop 15
    v_cvt_pk_bf16_f32 v84, v80, v81
    v_cvt_pk_bf16_f32 v85, v82, v83
    buffer_store_dwordx2 v[84:85], v7, s[8:11], 0 offen offset:320
    s_nop 0
    v_mov_b32 v80, 0
    v_mov_b32 v81, 0
    v_mov_b32 v82, 0
    v_mov_b32 v83, 0
    s_nop 1
    v_mfma_f32_16x16x16_bf16 v[80:83], v[170:171], v[60:61], v[80:83]
    v_mfma_f32_16x16x32_bf16 v[80:83], v[144:147], v[62:65], v[80:83]
    s_nop 15
    v_cvt_pk_bf16_f32 v84, v80, v81
    v_cvt_pk_bf16_f32 v85, v82, v83
    buffer_store_dwordx2 v[84:85], v6, s[8:11], 0 offen offset:352
    s_nop 0
    v_mov_b32 v80, 0
    v_mov_b32 v81, 0
    v_mov_b32 v82, 0
    v_mov_b32 v83, 0
    s_nop 1
    v_mfma_f32_16x16x16_bf16 v[80:83], v[170:171], v[66:67], v[80:83]
    v_mfma_f32_16x16x32_bf16 v[80:83], v[144:147], v[68:71], v[80:83]
    s_nop 15
    v_cvt_pk_bf16_f32 v84, v80, v81
    v_cvt_pk_bf16_f32 v85, v82, v83
    buffer_store_dwordx2 v[84:85], v7, s[8:11], 0 offen offset:352
    s_nop 0
Lat_end:
    s_endpgm
    .globl sequential_preLN__memory_aug_recurrent_mem_tr__mixer_channel_mlp__prompt_wo_kernel
    .p2align 8
    .type sequential_preLN__memory_aug_recurrent_mem_tr__mixer_channel_mlp__prompt_wo_kernel,@function
sequential_preLN__memory_aug_recurrent_mem_tr__mixer_channel_mlp__prompt_wo_kernel:
    s_cmp_ge_u32 s2, 320
    s_cbranch_scc1 Lwo_end
    s_load_dwordx2 s[4:5], s[0:1], 112
    s_waitcnt lgkmcnt(0)
    s_mov_b32 s8, s4
    s_and_b32 s9, s5, 0xffff
    s_mov_b32 s10, 0x10000000
    s_mov_b32 s11, 0x00020000
    s_load_dwordx2 s[6:7], s[0:1], 0
    v_and_b32 v1, 63, v0
    v_lshrrev_b32 v2, 6, v0
    s_mul_hi_u32 s37, s2, 0x8000000
    s_mul_i32 s36, s37, 32
    s_sub_u32 s36, s2, s36
    s_mul_i32 s36, s36, 64
    s_mul_i32 s37, s37, 64
    v_lshrrev_b32 v3, 3, v0
    v_and_b32 v4, 7, v0
    v_add_u32 v5, s36, v3
    s_mov_b32 s38, 12288
    v_mul_lo_u32 v5, v5, s38
    v_lshl_add_u32 v5, v4, 4, v5
    v_add_u32 v48, 0x8400000, v5
    v_add_u32 v49, 393216, v48
    v_add_u32 v5, s37, v3
    s_mov_b32 s38, 12288
    v_mul_lo_u32 v5, v5, s38
    v_lshl_add_u32 v5, v4, 4, v5
    v_add_u32 v52, 0x1c00000, v5
    v_add_u32 v53, 393216, v52
    v_mul_u32_u24 v58, 144, v3
    v_lshl_add_u32 v58, v4, 4, v58
    v_add_u32 v59, 9216, v58
    v_and_b32 v6, 31, v1
    v_lshrrev_b32 v7, 5, v1
    v_and_b32 v8, 1, v2
    v_lshrrev_b32 v9, 1, v2
    v_mul_u32_u24 v8, 32, v8
    v_add_u32 v8, v8, v6
    v_mul_u32_u24 v56, 144, v8
    v_lshl_add_u32 v56, v7, 4, v56
    v_mul_u32_u24 v9, 32, v9
    v_add_u32 v9, v9, v6
    v_mul_u32_u24 v57, 144, v9
    v_lshl_add_u32 v57, v7, 4, v57
    v_add_u32 v57, 9216, v57
    s_waitcnt lgkmcnt(0)
    s_mov_b32 s12, s6
    s_and_b32 s13, s7, 0xffff
    s_mov_b32 s14, 0x280000
    s_mov_b32 s15, 0x00020000
    v_mov_b32 v64, 0
    v_mov_b32 v65, 0
    v_mov_b32 v66, 0
    v_mov_b32 v67, 0
    v_mov_b32 v68, 0
    v_mov_b32 v69, 0
    v_mov_b32 v70, 0
    v_mov_b32 v71, 0
    v_mov_b32 v72, 0
    v_mov_b32 v73, 0
    v_mov_b32 v74, 0
    v_mov_b32 v75, 0
    v_mov_b32 v76, 0
    v_mov_b32 v77, 0
    v_mov_b32 v78, 0
    v_mov_b32 v79, 0
    s_mov_b32 s40, 0
    buffer_load_dwordx4 v[128:131], v48, s[8:11], s40 offen
    buffer_load_dwordx4 v[132:135], v49, s[8:11], s40 offen
    buffer_load_dwordx4 v[136:139], v52, s[8:11], s40 offen
    buffer_load_dwordx4 v[140:143], v53, s[8:11], s40 offen
    s_waitcnt vmcnt(0)
    ds_write_b128 v58, v[128:131] offset:0
    ds_write_b128 v58, v[132:135] offset:4608
    ds_write_b128 v59, v[136:139] offset:0
    ds_write_b128 v59, v[140:143] offset:4608
    s_mov_b32 s40, 128
    buffer_load_dwordx4 v[128:131], v48, s[8:11], s40 offen
    buffer_load_dwordx4 v[132:135], v49, s[8:11], s40 offen
    buffer_load_dwordx4 v[136:139], v52, s[8:11], s40 offen
    buffer_load_dwordx4 v[140:143], v53, s[8:11], s40 offen
    s_waitcnt lgkmcnt(0)
    s_barrier
    s_mov_b32 s41, 0
Lg_wo_loop:
    ds_read_b128 v[168:171], v56 offset:0
    ds_read_b128 v[172:175], v57 offset:0
    ds_read_b128 v[176:179], v56 offset:32
    ds_read_b128 v[180:183], v57 offset:32
    s_waitcnt lgkmcnt(2)
    v_mfma_f32_32x32x16_bf16 v[64:79], v[172:175], v[168:171], v[64:79]
    ds_read_b128 v[168:171], v56 offset:64
    ds_read_b128 v[172:175], v57 offset:64
    s_waitcnt lgkmcnt(2)
    v_mfma_f32_32x32x16_bf16 v[64:79], v[180:183], v[176:179], v[64:79]
    ds_read_b128 v[176:179], v56 offset:96
    ds_read_b128 v[180:183], v57 offset:96
    s_waitcnt lgkmcnt(2)
    v_mfma_f32_32x32x16_bf16 v[64:79], v[172:175], v[168:171], v[64:79]
    s_waitcnt lgkmcnt(0)
    v_mfma_f32_32x32x16_bf16 v[64:79], v[180:183], v[176:179], v[64:79]
    s_waitcnt vmcnt(0)
    ds_write_b128 v58, v[128:131] offset:18432
    ds_write_b128 v58, v[132:135] offset:23040
    ds_write_b128 v59, v[136:139] offset:18432
    ds_write_b128 v59, v[140:143] offset:23040
    s_add_u32 s40, s40, 128
    buffer_load_dwordx4 v[128:131], v48, s[8:11], s40 offen
    buffer_load_dwordx4 v[132:135], v49, s[8:11], s40 offen
    buffer_load_dwordx4 v[136:139], v52, s[8:11], s40 offen
    buffer_load_dwordx4 v[140:143], v53, s[8:11], s40 offen
    s_waitcnt lgkmcnt(0)
    s_barrier
    ds_read_b128 v[168:171], v56 offset:18432
    ds_read_b128 v[172:175], v57 offset:18432
    ds_read_b128 v[176:179], v56 offset:18464
    ds_read_b128 v[180:183], v57 offset:18464
    s_waitcnt lgkmcnt(2)
    v_mfma_f32_32x32x16_bf16 v[64:79], v[172:175], v[168:171], v[64:79]
    ds_read_b128 v[168:171], v56 offset:18496
    ds_read_b128 v[172:175], v57 offset:18496
    s_waitcnt lgkmcnt(2)
    v_mfma_f32_32x32x16_bf16 v[64:79], v[180:183], v[176:179], v[64:79]
    ds_read_b128 v[176:179], v56 offset:18528
    ds_read_b128 v[180:183], v57 offset:18528
    s_waitcnt lgkmcnt(2)
    v_mfma_f32_32x32x16_bf16 v[64:79], v[172:175], v[168:171], v[64:79]
    s_waitcnt lgkmcnt(0)
    v_mfma_f32_32x32x16_bf16 v[64:79], v[180:183], v[176:179], v[64:79]
    s_waitcnt vmcnt(0)
    ds_write_b128 v58, v[128:131] offset:0
    ds_write_b128 v58, v[132:135] offset:4608
    ds_write_b128 v59, v[136:139] offset:0
    ds_write_b128 v59, v[140:143] offset:4608
    s_add_u32 s40, s40, 128
    buffer_load_dwordx4 v[128:131], v48, s[8:11], s40 offen
    buffer_load_dwordx4 v[132:135], v49, s[8:11], s40 offen
    buffer_load_dwordx4 v[136:139], v52, s[8:11], s40 offen
    buffer_load_dwordx4 v[140:143], v53, s[8:11], s40 offen
    s_waitcnt lgkmcnt(0)
    s_barrier
    s_add_u32 s41, s41, 2
    s_cmp_lt_u32 s41, 96
    s_cbranch_scc1 Lg_wo_loop
    s_waitcnt vmcnt(0)
    s_nop 15
    s_nop 15
    v_add_u32 v10, s36, v8
    v_mul_u32_u24 v10, 1280, v10
    v_lshrrev_b32 v11, 1, v2
    v_lshlrev_b32 v11, 5, v11
    v_lshl_add_u32 v11, v7, 2, v11
    v_add_u32 v11, s37, v11
    v_lshl_add_u32 v10, v11, 1, v10
    v_add_u32 v14, 0x9c00000, v10
    buffer_load_dwordx2 v[16:17], v10, s[12:15], 0 offen offset:0
    v_cvt_pk_bf16_f32 v12, v64, v65
    v_cvt_pk_bf16_f32 v13, v66, v67
    s_waitcnt vmcnt(0)
    v_lshlrev_b32 v18, 16, v12
    v_and_b32 v19, 0xffff0000, v12
    v_lshlrev_b32 v20, 16, v16
    v_and_b32 v21, 0xffff0000, v16
    v_add_f32 v18, v18, v20
    v_add_f32 v19, v19, v21
    v_cvt_pk_bf16_f32 v12, v18, v19
    v_lshlrev_b32 v18, 16, v13
    v_and_b32 v19, 0xffff0000, v13
    v_lshlrev_b32 v20, 16, v17
    v_and_b32 v21, 0xffff0000, v17
    v_add_f32 v18, v18, v20
    v_add_f32 v19, v19, v21
    v_cvt_pk_bf16_f32 v13, v18, v19
    buffer_store_dwordx2 v[12:13], v14, s[8:11], 0 offen offset:0
    s_nop 0
    buffer_load_dwordx2 v[16:17], v10, s[12:15], 0 offen offset:16
    v_cvt_pk_bf16_f32 v12, v68, v69
    v_cvt_pk_bf16_f32 v13, v70, v71
    s_waitcnt vmcnt(0)
    v_lshlrev_b32 v18, 16, v12
    v_and_b32 v19, 0xffff0000, v12
    v_lshlrev_b32 v20, 16, v16
    v_and_b32 v21, 0xffff0000, v16
    v_add_f32 v18, v18, v20
    v_add_f32 v19, v19, v21
    v_cvt_pk_bf16_f32 v12, v18, v19
    v_lshlrev_b32 v18, 16, v13
    v_and_b32 v19, 0xffff0000, v13
    v_lshlrev_b32 v20, 16, v17
    v_and_b32 v21, 0xffff0000, v17
    v_add_f32 v18, v18, v20
    v_add_f32 v19, v19, v21
    v_cvt_pk_bf16_f32 v13, v18, v19
    buffer_store_dwordx2 v[12:13], v14, s[8:11], 0 offen offset:16
    s_nop 0
    buffer_load_dwordx2 v[16:17], v10, s[12:15], 0 offen offset:32
    v_cvt_pk_bf16_f32 v12, v72, v73
    v_cvt_pk_bf16_f32 v13, v74, v75
    s_waitcnt vmcnt(0)
    v_lshlrev_b32 v18, 16, v12
    v_and_b32 v19, 0xffff0000, v12
    v_lshlrev_b32 v20, 16, v16
    v_and_b32 v21, 0xffff0000, v16
    v_add_f32 v18, v18, v20
    v_add_f32 v19, v19, v21
    v_cvt_pk_bf16_f32 v12, v18, v19
    v_lshlrev_b32 v18, 16, v13
    v_and_b32 v19, 0xffff0000, v13
    v_lshlrev_b32 v20, 16, v17
    v_and_b32 v21, 0xffff0000, v17
    v_add_f32 v18, v18, v20
    v_add_f32 v19, v19, v21
    v_cvt_pk_bf16_f32 v13, v18, v19
    buffer_store_dwordx2 v[12:13], v14, s[8:11], 0 offen offset:32
    s_nop 0
    buffer_load_dwordx2 v[16:17], v10, s[12:15], 0 offen offset:48
    v_cvt_pk_bf16_f32 v12, v76, v77
    v_cvt_pk_bf16_f32 v13, v78, v79
    s_waitcnt vmcnt(0)
    v_lshlrev_b32 v18, 16, v12
    v_and_b32 v19, 0xffff0000, v12
    v_lshlrev_b32 v20, 16, v16
    v_and_b32 v21, 0xffff0000, v16
    v_add_f32 v18, v18, v20
    v_add_f32 v19, v19, v21
    v_cvt_pk_bf16_f32 v12, v18, v19
    v_lshlrev_b32 v18, 16, v13
    v_and_b32 v19, 0xffff0000, v13
    v_lshlrev_b32 v20, 16, v17
    v_and_b32 v21, 0xffff0000, v17
    v_add_f32 v18, v18, v20
    v_add_f32 v19, v19, v21
    v_cvt_pk_bf16_f32 v13, v18, v19
    buffer_store_dwordx2 v[12:13], v14, s[8:11], 0 offen offset:48
    s_nop 0
Lwo_end:
    s_endpgm
    .globl sequential_preLN__memory_aug_recurrent_mem_tr__mixer_channel_mlp__prompt_ln2_kernel
    .p2align 8
    .type sequential_preLN__memory_aug_recurrent_mem_tr__mixer_channel_mlp__prompt_ln2_kernel,@function
sequential_preLN__memory_aug_recurrent_mem_tr__mixer_channel_mlp__prompt_ln2_kernel:
    s_cmp_ge_u32 s2, 512
    s_cbranch_scc1 Lln2_end
    s_load_dwordx2 s[4:5], s[0:1], 112
    s_waitcnt lgkmcnt(0)
    s_mov_b32 s8, s4
    s_and_b32 s9, s5, 0xffff
    s_mov_b32 s10, 0x10000000
    s_mov_b32 s11, 0x00020000
    v_and_b32 v1, 63, v0
    v_lshrrev_b32 v2, 6, v0
    s_lshl_b32 s3, s2, 2
    v_add_u32 v3, s3, v2
    v_mul_u32_u24 v3, 1280, v3
    v_lshl_add_u32 v3, v1, 2, v3
    v_add_u32 v4, 0x9f00000, v3
    v_add_u32 v3, 0x9c00000, v3
    buffer_load_dword v20, v3, s[8:11], 0 offen offset:0
    buffer_load_dword v21, v3, s[8:11], 0 offen offset:256
    buffer_load_dword v22, v3, s[8:11], 0 offen offset:512
    buffer_load_dword v23, v3, s[8:11], 0 offen offset:768
    buffer_load_dword v24, v3, s[8:11], 0 offen offset:1024
    s_waitcnt vmcnt(0)
    v_lshlrev_b32 v10, 16, v20
    v_and_b32 v11, 0xffff0000, v20
    v_lshlrev_b32 v12, 16, v21
    v_and_b32 v13, 0xffff0000, v21
    v_lshlrev_b32 v14, 16, v22
    v_and_b32 v15, 0xffff0000, v22
    v_lshlrev_b32 v16, 16, v23
    v_and_b32 v17, 0xffff0000, v23
    v_lshlrev_b32 v18, 16, v24
    v_and_b32 v19, 0xffff0000, v24
    v_add_f32 v26, v10, v11
    v_add_f32 v26, v26, v12
    v_add_f32 v26, v26, v13
    v_add_f32 v26, v26, v14
    v_add_f32 v26, v26, v15
    v_add_f32 v26, v26, v16
    v_add_f32 v26, v26, v17
    v_add_f32 v26, v26, v18
    v_add_f32 v26, v26, v19
    v_xor_b32 v28, 1, v1
    v_lshlrev_b32 v28, 2, v28
    ds_bpermute_b32 v27, v28, v26
    s_waitcnt lgkmcnt(0)
    v_add_f32 v26, v26, v27
    v_xor_b32 v28, 2, v1
    v_lshlrev_b32 v28, 2, v28
    ds_bpermute_b32 v27, v28, v26
    s_waitcnt lgkmcnt(0)
    v_add_f32 v26, v26, v27
    v_xor_b32 v28, 4, v1
    v_lshlrev_b32 v28, 2, v28
    ds_bpermute_b32 v27, v28, v26
    s_waitcnt lgkmcnt(0)
    v_add_f32 v26, v26, v27
    v_xor_b32 v28, 8, v1
    v_lshlrev_b32 v28, 2, v28
    ds_bpermute_b32 v27, v28, v26
    s_waitcnt lgkmcnt(0)
    v_add_f32 v26, v26, v27
    v_xor_b32 v28, 16, v1
    v_lshlrev_b32 v28, 2, v28
    ds_bpermute_b32 v27, v28, v26
    s_waitcnt lgkmcnt(0)
    v_add_f32 v26, v26, v27
    v_xor_b32 v28, 32, v1
    v_lshlrev_b32 v28, 2, v28
    ds_bpermute_b32 v27, v28, v26
    s_waitcnt lgkmcnt(0)
    v_add_f32 v26, v26, v27
    v_mul_f32 v26, 0x3acccccd, v26
    v_mov_b32 v29, 0
    v_sub_f32 v27, v10, v26
    v_fmac_f32 v29, v27, v27
    v_sub_f32 v27, v11, v26
    v_fmac_f32 v29, v27, v27
    v_sub_f32 v27, v12, v26
    v_fmac_f32 v29, v27, v27
    v_sub_f32 v27, v13, v26
    v_fmac_f32 v29, v27, v27
    v_sub_f32 v27, v14, v26
    v_fmac_f32 v29, v27, v27
    v_sub_f32 v27, v15, v26
    v_fmac_f32 v29, v27, v27
    v_sub_f32 v27, v16, v26
    v_fmac_f32 v29, v27, v27
    v_sub_f32 v27, v17, v26
    v_fmac_f32 v29, v27, v27
    v_sub_f32 v27, v18, v26
    v_fmac_f32 v29, v27, v27
    v_sub_f32 v27, v19, v26
    v_fmac_f32 v29, v27, v27
    v_xor_b32 v28, 1, v1
    v_lshlrev_b32 v28, 2, v28
    ds_bpermute_b32 v27, v28, v29
    s_waitcnt lgkmcnt(0)
    v_add_f32 v29, v29, v27
    v_xor_b32 v28, 2, v1
    v_lshlrev_b32 v28, 2, v28
    ds_bpermute_b32 v27, v28, v29
    s_waitcnt lgkmcnt(0)
    v_add_f32 v29, v29, v27
    v_xor_b32 v28, 4, v1
    v_lshlrev_b32 v28, 2, v28
    ds_bpermute_b32 v27, v28, v29
    s_waitcnt lgkmcnt(0)
    v_add_f32 v29, v29, v27
    v_xor_b32 v28, 8, v1
    v_lshlrev_b32 v28, 2, v28
    ds_bpermute_b32 v27, v28, v29
    s_waitcnt lgkmcnt(0)
    v_add_f32 v29, v29, v27
    v_xor_b32 v28, 16, v1
    v_lshlrev_b32 v28, 2, v28
    ds_bpermute_b32 v27, v28, v29
    s_waitcnt lgkmcnt(0)
    v_add_f32 v29, v29, v27
    v_xor_b32 v28, 32, v1
    v_lshlrev_b32 v28, 2, v28
    ds_bpermute_b32 v27, v28, v29
    s_waitcnt lgkmcnt(0)
    v_add_f32 v29, v29, v27
    v_mul_f32 v29, 0x3acccccd, v29
    v_cvt_pk_bf16_f32 v27, v26, v29
    v_lshlrev_b32 v26, 16, v27
    v_and_b32 v29, 0xffff0000, v27
    v_add_f32 v29, 0x3727c5ac, v29
    v_cvt_pk_bf16_f32 v27, v29, v29
    v_lshlrev_b32 v29, 16, v27
    v_sqrt_f32 v29, v29
    s_nop 0
    v_cvt_pk_bf16_f32 v27, v29, v29
    v_lshlrev_b32 v29, 16, v27
    v_rcp_f32 v29, v29
    s_nop 0
    v_sub_f32 v10, v10, v26
    v_sub_f32 v11, v11, v26
    v_cvt_pk_bf16_f32 v27, v10, v11
    v_lshlrev_b32 v10, 16, v27
    v_and_b32 v11, 0xffff0000, v27
    v_mul_f32 v10, v10, v29
    v_mul_f32 v11, v11, v29
    v_cvt_pk_bf16_f32 v20, v10, v11
    v_lshlrev_b32 v10, 16, v20
    v_and_b32 v11, 0xffff0000, v20
    v_sub_f32 v12, v12, v26
    v_sub_f32 v13, v13, v26
    v_cvt_pk_bf16_f32 v27, v12, v13
    v_lshlrev_b32 v12, 16, v27
    v_and_b32 v13, 0xffff0000, v27
    v_mul_f32 v12, v12, v29
    v_mul_f32 v13, v13, v29
    v_cvt_pk_bf16_f32 v21, v12, v13
    v_lshlrev_b32 v12, 16, v21
    v_and_b32 v13, 0xffff0000, v21
    v_sub_f32 v14, v14, v26
    v_sub_f32 v15, v15, v26
    v_cvt_pk_bf16_f32 v27, v14, v15
    v_lshlrev_b32 v14, 16, v27
    v_and_b32 v15, 0xffff0000, v27
    v_mul_f32 v14, v14, v29
    v_mul_f32 v15, v15, v29
    v_cvt_pk_bf16_f32 v22, v14, v15
    v_lshlrev_b32 v14, 16, v22
    v_and_b32 v15, 0xffff0000, v22
    v_sub_f32 v16, v16, v26
    v_sub_f32 v17, v17, v26
    v_cvt_pk_bf16_f32 v27, v16, v17
    v_lshlrev_b32 v16, 16, v27
    v_and_b32 v17, 0xffff0000, v27
    v_mul_f32 v16, v16, v29
    v_mul_f32 v17, v17, v29
    v_cvt_pk_bf16_f32 v23, v16, v17
    v_lshlrev_b32 v16, 16, v23
    v_and_b32 v17, 0xffff0000, v23
    v_sub_f32 v18, v18, v26
    v_sub_f32 v19, v19, v26
    v_cvt_pk_bf16_f32 v27, v18, v19
    v_lshlrev_b32 v18, 16, v27
    v_and_b32 v19, 0xffff0000, v27
    v_mul_f32 v18, v18, v29
    v_mul_f32 v19, v19, v29
    v_cvt_pk_bf16_f32 v24, v18, v19
    v_lshlrev_b32 v18, 16, v24
    v_and_b32 v19, 0xffff0000, v24
    v_add_f32 v26, v10, v11
    v_add_f32 v26, v26, v12
    v_add_f32 v26, v26, v13
    v_add_f32 v26, v26, v14
    v_add_f32 v26, v26, v15
    v_add_f32 v26, v26, v16
    v_add_f32 v26, v26, v17
    v_add_f32 v26, v26, v18
    v_add_f32 v26, v26, v19
    v_xor_b32 v28, 1, v1
    v_lshlrev_b32 v28, 2, v28
    ds_bpermute_b32 v27, v28, v26
    s_waitcnt lgkmcnt(0)
    v_add_f32 v26, v26, v27
    v_xor_b32 v28, 2, v1
    v_lshlrev_b32 v28, 2, v28
    ds_bpermute_b32 v27, v28, v26
    s_waitcnt lgkmcnt(0)
    v_add_f32 v26, v26, v27
    v_xor_b32 v28, 4, v1
    v_lshlrev_b32 v28, 2, v28
    ds_bpermute_b32 v27, v28, v26
    s_waitcnt lgkmcnt(0)
    v_add_f32 v26, v26, v27
    v_xor_b32 v28, 8, v1
    v_lshlrev_b32 v28, 2, v28
    ds_bpermute_b32 v27, v28, v26
    s_waitcnt lgkmcnt(0)
    v_add_f32 v26, v26, v27
    v_xor_b32 v28, 16, v1
    v_lshlrev_b32 v28, 2, v28
    ds_bpermute_b32 v27, v28, v26
    s_waitcnt lgkmcnt(0)
    v_add_f32 v26, v26, v27
    v_xor_b32 v28, 32, v1
    v_lshlrev_b32 v28, 2, v28
    ds_bpermute_b32 v27, v28, v26
    s_waitcnt lgkmcnt(0)
    v_add_f32 v26, v26, v27
    v_mul_f32 v26, 0x3acccccd, v26
    v_mov_b32 v29, 0
    v_sub_f32 v27, v10, v26
    v_fmac_f32 v29, v27, v27
    v_sub_f32 v27, v11, v26
    v_fmac_f32 v29, v27, v27
    v_sub_f32 v27, v12, v26
    v_fmac_f32 v29, v27, v27
    v_sub_f32 v27, v13, v26
    v_fmac_f32 v29, v27, v27
    v_sub_f32 v27, v14, v26
    v_fmac_f32 v29, v27, v27
    v_sub_f32 v27, v15, v26
    v_fmac_f32 v29, v27, v27
    v_sub_f32 v27, v16, v26
    v_fmac_f32 v29, v27, v27
    v_sub_f32 v27, v17, v26
    v_fmac_f32 v29, v27, v27
    v_sub_f32 v27, v18, v26
    v_fmac_f32 v29, v27, v27
    v_sub_f32 v27, v19, v26
    v_fmac_f32 v29, v27, v27
    v_xor_b32 v28, 1, v1
    v_lshlrev_b32 v28, 2, v28
    ds_bpermute_b32 v27, v28, v29
    s_waitcnt lgkmcnt(0)
    v_add_f32 v29, v29, v27
    v_xor_b32 v28, 2, v1
    v_lshlrev_b32 v28, 2, v28
    ds_bpermute_b32 v27, v28, v29
    s_waitcnt lgkmcnt(0)
    v_add_f32 v29, v29, v27
    v_xor_b32 v28, 4, v1
    v_lshlrev_b32 v28, 2, v28
    ds_bpermute_b32 v27, v28, v29
    s_waitcnt lgkmcnt(0)
    v_add_f32 v29, v29, v27
    v_xor_b32 v28, 8, v1
    v_lshlrev_b32 v28, 2, v28
    ds_bpermute_b32 v27, v28, v29
    s_waitcnt lgkmcnt(0)
    v_add_f32 v29, v29, v27
    v_xor_b32 v28, 16, v1
    v_lshlrev_b32 v28, 2, v28
    ds_bpermute_b32 v27, v28, v29
    s_waitcnt lgkmcnt(0)
    v_add_f32 v29, v29, v27
    v_xor_b32 v28, 32, v1
    v_lshlrev_b32 v28, 2, v28
    ds_bpermute_b32 v27, v28, v29
    s_waitcnt lgkmcnt(0)
    v_add_f32 v29, v29, v27
    v_mul_f32 v29, 0x3acccccd, v29
    v_cvt_pk_bf16_f32 v27, v26, v29
    v_lshlrev_b32 v26, 16, v27
    v_and_b32 v29, 0xffff0000, v27
    v_add_f32 v29, 0x3727c5ac, v29
    v_cvt_pk_bf16_f32 v27, v29, v29
    v_lshlrev_b32 v29, 16, v27
    v_sqrt_f32 v29, v29
    s_nop 0
    v_cvt_pk_bf16_f32 v27, v29, v29
    v_lshlrev_b32 v29, 16, v27
    v_rcp_f32 v29, v29
    s_nop 0
    v_sub_f32 v10, v10, v26
    v_sub_f32 v11, v11, v26
    v_cvt_pk_bf16_f32 v27, v10, v11
    v_lshlrev_b32 v10, 16, v27
    v_and_b32 v11, 0xffff0000, v27
    v_mul_f32 v10, v10, v29
    v_mul_f32 v11, v11, v29
    v_cvt_pk_bf16_f32 v20, v10, v11
    v_lshlrev_b32 v10, 16, v20
    v_and_b32 v11, 0xffff0000, v20
    v_sub_f32 v12, v12, v26
    v_sub_f32 v13, v13, v26
    v_cvt_pk_bf16_f32 v27, v12, v13
    v_lshlrev_b32 v12, 16, v27
    v_and_b32 v13, 0xffff0000, v27
    v_mul_f32 v12, v12, v29
    v_mul_f32 v13, v13, v29
    v_cvt_pk_bf16_f32 v21, v12, v13
    v_lshlrev_b32 v12, 16, v21
    v_and_b32 v13, 0xffff0000, v21
    v_sub_f32 v14, v14, v26
    v_sub_f32 v15, v15, v26
    v_cvt_pk_bf16_f32 v27, v14, v15
    v_lshlrev_b32 v14, 16, v27
    v_and_b32 v15, 0xffff0000, v27
    v_mul_f32 v14, v14, v29
    v_mul_f32 v15, v15, v29
    v_cvt_pk_bf16_f32 v22, v14, v15
    v_lshlrev_b32 v14, 16, v22
    v_and_b32 v15, 0xffff0000, v22
    v_sub_f32 v16, v16, v26
    v_sub_f32 v17, v17, v26
    v_cvt_pk_bf16_f32 v27, v16, v17
    v_lshlrev_b32 v16, 16, v27
    v_and_b32 v17, 0xffff0000, v27
    v_mul_f32 v16, v16, v29
    v_mul_f32 v17, v17, v29
    v_cvt_pk_bf16_f32 v23, v16, v17
    v_lshlrev_b32 v16, 16, v23
    v_and_b32 v17, 0xffff0000, v23
    v_sub_f32 v18, v18, v26
    v_sub_f32 v19, v19, v26
    v_cvt_pk_bf16_f32 v27, v18, v19
    v_lshlrev_b32 v18, 16, v27
    v_and_b32 v19, 0xffff0000, v27
    v_mul_f32 v18, v18, v29
    v_mul_f32 v19, v19, v29
    v_cvt_pk_bf16_f32 v24, v18, v19
    v_lshlrev_b32 v18, 16, v24
    v_and_b32 v19, 0xffff0000, v24
    buffer_store_dword v20, v4, s[8:11], 0 offen offset:0
    buffer_store_dword v21, v4, s[8:11], 0 offen offset:256
    buffer_store_dword v22, v4, s[8:11], 0 offen offset:512
    buffer_store_dword v23, v4, s[8:11], 0 offen offset:768
    buffer_store_dword v24, v4, s[8:11], 0 offen offset:1024
Lln2_end:
    s_endpgm
    .globl sequential_preLN__memory_aug_recurrent_mem_tr__mixer_channel_mlp__prompt_mlp1_kernel
    .p2align 8
    .type sequential_preLN__memory_aug_recurrent_mem_tr__mixer_channel_mlp__prompt_mlp1_kernel,@function
sequential_preLN__memory_aug_recurrent_mem_tr__mixer_channel_mlp__prompt_mlp1_kernel:
    s_cmp_ge_u32 s2, 192
    s_cbranch_scc1 Lm1_end
    s_load_dwordx2 s[4:5], s[0:1], 112
    s_waitcnt lgkmcnt(0)
    s_mov_b32 s8, s4
    s_and_b32 s9, s5, 0xffff
    s_mov_b32 s10, 0x10000000
    s_mov_b32 s11, 0x00020000
    s_load_dwordx2 s[6:7], s[0:1], 72
    v_and_b32 v1, 63, v0
    v_lshrrev_b32 v2, 6, v0
    s_mul_hi_u32 s37, s2, 0x10000000
    s_mul_i32 s36, s37, 16
    s_sub_u32 s36, s2, s36
    s_mul_i32 s36, s36, 128
    s_mul_i32 s37, s37, 128
    v_lshrrev_b32 v3, 3, v0
    v_and_b32 v4, 7, v0
    v_add_u32 v5, s36, v3
    s_mov_b32 s38, 1280
    v_mul_lo_u32 v5, v5, s38
    v_lshl_add_u32 v5, v4, 4, v5
    v_add_u32 v48, 0x9f00000, v5
    v_add_u32 v49, 40960, v48
    v_add_u32 v50, 40960, v49
    v_add_u32 v51, 40960, v50
    v_add_u32 v5, s37, v3
    s_mov_b32 s38, 1280
    v_mul_lo_u32 v5, v5, s38
    v_lshl_add_u32 v5, v4, 4, v5
    v_add_u32 v52, 0x2400000, v5
    v_add_u32 v53, 40960, v52
    v_add_u32 v54, 40960, v53
    v_add_u32 v55, 40960, v54
    v_mul_u32_u24 v58, 144, v3
    v_lshl_add_u32 v58, v4, 4, v58
    v_add_u32 v59, 18432, v58
    v_and_b32 v6, 31, v1
    v_lshrrev_b32 v7, 5, v1
    v_and_b32 v8, 1, v2
    v_lshrrev_b32 v9, 1, v2
    v_mul_u32_u24 v8, 64, v8
    v_add_u32 v8, v8, v6
    v_mul_u32_u24 v56, 144, v8
    v_lshl_add_u32 v56, v7, 4, v56
    v_mul_u32_u24 v9, 64, v9
    v_add_u32 v9, v9, v6
    v_mul_u32_u24 v57, 144, v9
    v_lshl_add_u32 v57, v7, 4, v57
    v_add_u32 v57, 18432, v57
    s_waitcnt lgkmcnt(0)
    s_mov_b32 s12, s6
    s_and_b32 s13, s7, 0xffff
    s_mov_b32 s14, 0xc00
    s_mov_b32 s15, 0x00020000
    v_mov_b32 v64, 0
    v_mov_b32 v65, 0
    v_mov_b32 v66, 0
    v_mov_b32 v67, 0
    v_mov_b32 v68, 0
    v_mov_b32 v69, 0
    v_mov_b32 v70, 0
    v_mov_b32 v71, 0
    v_mov_b32 v72, 0
    v_mov_b32 v73, 0
    v_mov_b32 v74, 0
    v_mov_b32 v75, 0
    v_mov_b32 v76, 0
    v_mov_b32 v77, 0
    v_mov_b32 v78, 0
    v_mov_b32 v79, 0
    v_mov_b32 v80, 0
    v_mov_b32 v81, 0
    v_mov_b32 v82, 0
    v_mov_b32 v83, 0
    v_mov_b32 v84, 0
    v_mov_b32 v85, 0
    v_mov_b32 v86, 0
    v_mov_b32 v87, 0
    v_mov_b32 v88, 0
    v_mov_b32 v89, 0
    v_mov_b32 v90, 0
    v_mov_b32 v91, 0
    v_mov_b32 v92, 0
    v_mov_b32 v93, 0
    v_mov_b32 v94, 0
    v_mov_b32 v95, 0
    v_mov_b32 v96, 0
    v_mov_b32 v97, 0
    v_mov_b32 v98, 0
    v_mov_b32 v99, 0
    v_mov_b32 v100, 0
    v_mov_b32 v101, 0
    v_mov_b32 v102, 0
    v_mov_b32 v103, 0
    v_mov_b32 v104, 0
    v_mov_b32 v105, 0
    v_mov_b32 v106, 0
    v_mov_b32 v107, 0
    v_mov_b32 v108, 0
    v_mov_b32 v109, 0
    v_mov_b32 v110, 0
    v_mov_b32 v111, 0
    v_mov_b32 v112, 0
    v_mov_b32 v113, 0
    v_mov_b32 v114, 0
    v_mov_b32 v115, 0
    v_mov_b32 v116, 0
    v_mov_b32 v117, 0
    v_mov_b32 v118, 0
    v_mov_b32 v119, 0
    v_mov_b32 v120, 0
    v_mov_b32 v121, 0
    v_mov_b32 v122, 0
    v_mov_b32 v123, 0
    v_mov_b32 v124, 0
    v_mov_b32 v125, 0
    v_mov_b32 v126, 0
    v_mov_b32 v127, 0
    s_mov_b32 s40, 0
    buffer_load_dwordx4 v[128:131], v48, s[8:11], s40 offen
    buffer_load_dwordx4 v[132:135], v49, s[8:11], s40 offen
    buffer_load_dwordx4 v[136:139], v50, s[8:11], s40 offen
    buffer_load_dwordx4 v[140:143], v51, s[8:11], s40 offen
    buffer_load_dwordx4 v[144:147], v52, s[8:11], s40 offen
    buffer_load_dwordx4 v[148:151], v53, s[8:11], s40 offen
    buffer_load_dwordx4 v[152:155], v54, s[8:11], s40 offen
    buffer_load_dwordx4 v[156:159], v55, s[8:11], s40 offen
    s_waitcnt vmcnt(0)
    ds_write_b128 v58, v[128:131] offset:0
    ds_write_b128 v58, v[132:135] offset:4608
    ds_write_b128 v58, v[136:139] offset:9216
    ds_write_b128 v58, v[140:143] offset:13824
    ds_write_b128 v59, v[144:147] offset:0
    ds_write_b128 v59, v[148:151] offset:4608
    ds_write_b128 v59, v[152:155] offset:9216
    ds_write_b128 v59, v[156:159] offset:13824
    s_mov_b32 s40, 128
    buffer_load_dwordx4 v[128:131], v48, s[8:11], s40 offen
    buffer_load_dwordx4 v[132:135], v49, s[8:11], s40 offen
    buffer_load_dwordx4 v[136:139], v50, s[8:11], s40 offen
    buffer_load_dwordx4 v[140:143], v51, s[8:11], s40 offen
    buffer_load_dwordx4 v[144:147], v52, s[8:11], s40 offen
    buffer_load_dwordx4 v[148:151], v53, s[8:11], s40 offen
    buffer_load_dwordx4 v[152:155], v54, s[8:11], s40 offen
    buffer_load_dwordx4 v[156:159], v55, s[8:11], s40 offen
    s_waitcnt lgkmcnt(0)
    s_barrier
    s_mov_b32 s41, 0
Lg_m1_loop:
    ds_read_b128 v[168:171], v56 offset:0
    ds_read_b128 v[172:175], v56 offset:4608
    ds_read_b128 v[176:179], v57 offset:0
    ds_read_b128 v[180:183], v57 offset:4608
    ds_read_b128 v[184:187], v56 offset:32
    ds_read_b128 v[188:191], v56 offset:4640
    ds_read_b128 v[192:195], v57 offset:32
    ds_read_b128 v[196:199], v57 offset:4640
    s_waitcnt lgkmcnt(4)
    v_mfma_f32_32x32x16_bf16 v[64:79], v[176:179], v[168:171], v[64:79]
    v_mfma_f32_32x32x16_bf16 v[80:95], v[180:183], v[168:171], v[80:95]
    v_mfma_f32_32x32x16_bf16 v[96:111], v[176:179], v[172:175], v[96:111]
    v_mfma_f32_32x32x16_bf16 v[112:127], v[180:183], v[172:175], v[112:127]
    ds_read_b128 v[168:171], v56 offset:64
    ds_read_b128 v[172:175], v56 offset:4672
    ds_read_b128 v[176:179], v57 offset:64
    ds_read_b128 v[180:183], v57 offset:4672
    s_waitcnt lgkmcnt(4)
    v_mfma_f32_32x32x16_bf16 v[64:79], v[192:195], v[184:187], v[64:79]
    v_mfma_f32_32x32x16_bf16 v[80:95], v[196:199], v[184:187], v[80:95]
    v_mfma_f32_32x32x16_bf16 v[96:111], v[192:195], v[188:191], v[96:111]
    v_mfma_f32_32x32x16_bf16 v[112:127], v[196:199], v[188:191], v[112:127]
    ds_read_b128 v[184:187], v56 offset:96
    ds_read_b128 v[188:191], v56 offset:4704
    ds_read_b128 v[192:195], v57 offset:96
    ds_read_b128 v[196:199], v57 offset:4704
    s_waitcnt lgkmcnt(4)
    v_mfma_f32_32x32x16_bf16 v[64:79], v[176:179], v[168:171], v[64:79]
    v_mfma_f32_32x32x16_bf16 v[80:95], v[180:183], v[168:171], v[80:95]
    v_mfma_f32_32x32x16_bf16 v[96:111], v[176:179], v[172:175], v[96:111]
    v_mfma_f32_32x32x16_bf16 v[112:127], v[180:183], v[172:175], v[112:127]
    s_waitcnt lgkmcnt(0)
    v_mfma_f32_32x32x16_bf16 v[64:79], v[192:195], v[184:187], v[64:79]
    v_mfma_f32_32x32x16_bf16 v[80:95], v[196:199], v[184:187], v[80:95]
    v_mfma_f32_32x32x16_bf16 v[96:111], v[192:195], v[188:191], v[96:111]
    v_mfma_f32_32x32x16_bf16 v[112:127], v[196:199], v[188:191], v[112:127]
    s_waitcnt vmcnt(0)
    ds_write_b128 v58, v[128:131] offset:36864
    ds_write_b128 v58, v[132:135] offset:41472
    ds_write_b128 v58, v[136:139] offset:46080
    ds_write_b128 v58, v[140:143] offset:50688
    ds_write_b128 v59, v[144:147] offset:36864
    ds_write_b128 v59, v[148:151] offset:41472
    ds_write_b128 v59, v[152:155] offset:46080
    ds_write_b128 v59, v[156:159] offset:50688
    s_add_u32 s40, s40, 128
    buffer_load_dwordx4 v[128:131], v48, s[8:11], s40 offen
    buffer_load_dwordx4 v[132:135], v49, s[8:11], s40 offen
    buffer_load_dwordx4 v[136:139], v50, s[8:11], s40 offen
    buffer_load_dwordx4 v[140:143], v51, s[8:11], s40 offen
    buffer_load_dwordx4 v[144:147], v52, s[8:11], s40 offen
    buffer_load_dwordx4 v[148:151], v53, s[8:11], s40 offen
    buffer_load_dwordx4 v[152:155], v54, s[8:11], s40 offen
    buffer_load_dwordx4 v[156:159], v55, s[8:11], s40 offen
    s_waitcnt lgkmcnt(0)
    s_barrier
    ds_read_b128 v[168:171], v56 offset:36864
    ds_read_b128 v[172:175], v56 offset:41472
    ds_read_b128 v[176:179], v57 offset:36864
    ds_read_b128 v[180:183], v57 offset:41472
    ds_read_b128 v[184:187], v56 offset:36896
    ds_read_b128 v[188:191], v56 offset:41504
    ds_read_b128 v[192:195], v57 offset:36896
    ds_read_b128 v[196:199], v57 offset:41504
    s_waitcnt lgkmcnt(4)
    v_mfma_f32_32x32x16_bf16 v[64:79], v[176:179], v[168:171], v[64:79]
    v_mfma_f32_32x32x16_bf16 v[80:95], v[180:183], v[168:171], v[80:95]
    v_mfma_f32_32x32x16_bf16 v[96:111], v[176:179], v[172:175], v[96:111]
    v_mfma_f32_32x32x16_bf16 v[112:127], v[180:183], v[172:175], v[112:127]
    ds_read_b128 v[168:171], v56 offset:36928
    ds_read_b128 v[172:175], v56 offset:41536
    ds_read_b128 v[176:179], v57 offset:36928
    ds_read_b128 v[180:183], v57 offset:41536
    s_waitcnt lgkmcnt(4)
    v_mfma_f32_32x32x16_bf16 v[64:79], v[192:195], v[184:187], v[64:79]
    v_mfma_f32_32x32x16_bf16 v[80:95], v[196:199], v[184:187], v[80:95]
    v_mfma_f32_32x32x16_bf16 v[96:111], v[192:195], v[188:191], v[96:111]
    v_mfma_f32_32x32x16_bf16 v[112:127], v[196:199], v[188:191], v[112:127]
    ds_read_b128 v[184:187], v56 offset:36960
    ds_read_b128 v[188:191], v56 offset:41568
    ds_read_b128 v[192:195], v57 offset:36960
    ds_read_b128 v[196:199], v57 offset:41568
    s_waitcnt lgkmcnt(4)
    v_mfma_f32_32x32x16_bf16 v[64:79], v[176:179], v[168:171], v[64:79]
    v_mfma_f32_32x32x16_bf16 v[80:95], v[180:183], v[168:171], v[80:95]
    v_mfma_f32_32x32x16_bf16 v[96:111], v[176:179], v[172:175], v[96:111]
    v_mfma_f32_32x32x16_bf16 v[112:127], v[180:183], v[172:175], v[112:127]
    s_waitcnt lgkmcnt(0)
    v_mfma_f32_32x32x16_bf16 v[64:79], v[192:195], v[184:187], v[64:79]
    v_mfma_f32_32x32x16_bf16 v[80:95], v[196:199], v[184:187], v[80:95]
    v_mfma_f32_32x32x16_bf16 v[96:111], v[192:195], v[188:191], v[96:111]
    v_mfma_f32_32x32x16_bf16 v[112:127], v[196:199], v[188:191], v[112:127]
    s_waitcnt vmcnt(0)
    ds_write_b128 v58, v[128:131] offset:0
    ds_write_b128 v58, v[132:135] offset:4608
    ds_write_b128 v58, v[136:139] offset:9216
    ds_write_b128 v58, v[140:143] offset:13824
    ds_write_b128 v59, v[144:147] offset:0
    ds_write_b128 v59, v[148:151] offset:4608
    ds_write_b128 v59, v[152:155] offset:9216
    ds_write_b128 v59, v[156:159] offset:13824
    s_add_u32 s40, s40, 128
    buffer_load_dwordx4 v[128:131], v48, s[8:11], s40 offen
    buffer_load_dwordx4 v[132:135], v49, s[8:11], s40 offen
    buffer_load_dwordx4 v[136:139], v50, s[8:11], s40 offen
    buffer_load_dwordx4 v[140:143], v51, s[8:11], s40 offen
    buffer_load_dwordx4 v[144:147], v52, s[8:11], s40 offen
    buffer_load_dwordx4 v[148:151], v53, s[8:11], s40 offen
    buffer_load_dwordx4 v[152:155], v54, s[8:11], s40 offen
    buffer_load_dwordx4 v[156:159], v55, s[8:11], s40 offen
    s_waitcnt lgkmcnt(0)
    s_barrier
    s_add_u32 s41, s41, 2
    s_cmp_lt_u32 s41, 10
    s_cbranch_scc1 Lg_m1_loop
    s_waitcnt vmcnt(0)
    s_nop 15
    s_nop 15
    v_add_u32 v10, s36, v8
    v_mul_u32_u24 v10, 3072, v10
    v_lshrrev_b32 v11, 1, v2
    v_lshlrev_b32 v11, 6, v11
    v_lshl_add_u32 v11, v7, 2, v11
    v_add_u32 v11, s37, v11
    v_lshlrev_b32 v11, 1, v11
    v_add_u32 v10, v10, v11
    v_add_u32 v10, 0xa200000, v10
    s_mov_b32 s38, 0x3d372713
    s_mov_b32 s39, 0xc0135761
    buffer_load_dwordx2 v[16:17], v11, s[12:15], 0 offen offset:0
    v_cvt_pk_bf16_f32 v12, v64, v65
    v_cvt_pk_bf16_f32 v13, v66, v67
    s_waitcnt vmcnt(0)
    v_lshlrev_b32 v18, 16, v12
    v_and_b32 v19, 0xffff0000, v12
    v_lshlrev_b32 v20, 16, v16
    v_and_b32 v21, 0xffff0000, v16
    v_add_f32 v18, v18, v20
    v_add_f32 v19, v19, v21
    v_cvt_pk_bf16_f32 v22, v18, v19
    v_lshlrev_b32 v18, 16, v22
    v_and_b32 v19, 0xffff0000, v22
    v_mul_f32 v23, v18, v18
    v_mul_f32 v23, v23, v18
    v_fma_f32 v23, v23, s38, v18
    v_mul_f32 v23, s39, v23
    v_exp_f32 v23, v23
    s_nop 0
    v_add_f32 v23, 1.0, v23
    v_rcp_f32 v23, v23
    s_nop 0
    v_mul_f32 v18, v18, v23
    v_mul_f32 v23, v19, v19
    v_mul_f32 v23, v23, v19
    v_fma_f32 v23, v23, s38, v19
    v_mul_f32 v23, s39, v23
    v_exp_f32 v23, v23
    s_nop 0
    v_add_f32 v23, 1.0, v23
    v_rcp_f32 v23, v23
    s_nop 0
    v_mul_f32 v19, v19, v23
    v_cvt_pk_bf16_f32 v12, v18, v19
    v_lshlrev_b32 v18, 16, v13
    v_and_b32 v19, 0xffff0000, v13
    v_lshlrev_b32 v20, 16, v17
    v_and_b32 v21, 0xffff0000, v17
    v_add_f32 v18, v18, v20
    v_add_f32 v19, v19, v21
    v_cvt_pk_bf16_f32 v22, v18, v19
    v_lshlrev_b32 v18, 16, v22
    v_and_b32 v19, 0xffff0000, v22
    v_mul_f32 v23, v18, v18
    v_mul_f32 v23, v23, v18
    v_fma_f32 v23, v23, s38, v18
    v_mul_f32 v23, s39, v23
    v_exp_f32 v23, v23
    s_nop 0
    v_add_f32 v23, 1.0, v23
    v_rcp_f32 v23, v23
    s_nop 0
    v_mul_f32 v18, v18, v23
    v_mul_f32 v23, v19, v19
    v_mul_f32 v23, v23, v19
    v_fma_f32 v23, v23, s38, v19
    v_mul_f32 v23, s39, v23
    v_exp_f32 v23, v23
    s_nop 0
    v_add_f32 v23, 1.0, v23
    v_rcp_f32 v23, v23
    s_nop 0
    v_mul_f32 v19, v19, v23
    v_cvt_pk_bf16_f32 v13, v18, v19
    buffer_store_dwordx2 v[12:13], v10, s[8:11], 0 offen offset:0
    s_nop 0
    buffer_load_dwordx2 v[16:17], v11, s[12:15], 0 offen offset:16
    v_cvt_pk_bf16_f32 v12, v68, v69
    v_cvt_pk_bf16_f32 v13, v70, v71
    s_waitcnt vmcnt(0)
    v_lshlrev_b32 v18, 16, v12
    v_and_b32 v19, 0xffff0000, v12
    v_lshlrev_b32 v20, 16, v16
    v_and_b32 v21, 0xffff0000, v16
    v_add_f32 v18, v18, v20
    v_add_f32 v19, v19, v21
    v_cvt_pk_bf16_f32 v22, v18, v19
    v_lshlrev_b32 v18, 16, v22
    v_and_b32 v19, 0xffff0000, v22
    v_mul_f32 v23, v18, v18
    v_mul_f32 v23, v23, v18
    v_fma_f32 v23, v23, s38, v18
    v_mul_f32 v23, s39, v23
    v_exp_f32 v23, v23
    s_nop 0
    v_add_f32 v23, 1.0, v23
    v_rcp_f32 v23, v23
    s_nop 0
    v_mul_f32 v18, v18, v23
    v_mul_f32 v23, v19, v19
    v_mul_f32 v23, v23, v19
    v_fma_f32 v23, v23, s38, v19
    v_mul_f32 v23, s39, v23
    v_exp_f32 v23, v23
    s_nop 0
    v_add_f32 v23, 1.0, v23
    v_rcp_f32 v23, v23
    s_nop 0
    v_mul_f32 v19, v19, v23
    v_cvt_pk_bf16_f32 v12, v18, v19
    v_lshlrev_b32 v18, 16, v13
    v_and_b32 v19, 0xffff0000, v13
    v_lshlrev_b32 v20, 16, v17
    v_and_b32 v21, 0xffff0000, v17
    v_add_f32 v18, v18, v20
    v_add_f32 v19, v19, v21
    v_cvt_pk_bf16_f32 v22, v18, v19
    v_lshlrev_b32 v18, 16, v22
    v_and_b32 v19, 0xffff0000, v22
    v_mul_f32 v23, v18, v18
    v_mul_f32 v23, v23, v18
    v_fma_f32 v23, v23, s38, v18
    v_mul_f32 v23, s39, v23
    v_exp_f32 v23, v23
    s_nop 0
    v_add_f32 v23, 1.0, v23
    v_rcp_f32 v23, v23
    s_nop 0
    v_mul_f32 v18, v18, v23
    v_mul_f32 v23, v19, v19
    v_mul_f32 v23, v23, v19
    v_fma_f32 v23, v23, s38, v19
    v_mul_f32 v23, s39, v23
    v_exp_f32 v23, v23
    s_nop 0
    v_add_f32 v23, 1.0, v23
    v_rcp_f32 v23, v23
    s_nop 0
    v_mul_f32 v19, v19, v23
    v_cvt_pk_bf16_f32 v13, v18, v19
    buffer_store_dwordx2 v[12:13], v10, s[8:11], 0 offen offset:16
    s_nop 0
    buffer_load_dwordx2 v[16:17], v11, s[12:15], 0 offen offset:32
    v_cvt_pk_bf16_f32 v12, v72, v73
    v_cvt_pk_bf16_f32 v13, v74, v75
    s_waitcnt vmcnt(0)
    v_lshlrev_b32 v18, 16, v12
    v_and_b32 v19, 0xffff0000, v12
    v_lshlrev_b32 v20, 16, v16
    v_and_b32 v21, 0xffff0000, v16
    v_add_f32 v18, v18, v20
    v_add_f32 v19, v19, v21
    v_cvt_pk_bf16_f32 v22, v18, v19
    v_lshlrev_b32 v18, 16, v22
    v_and_b32 v19, 0xffff0000, v22
    v_mul_f32 v23, v18, v18
    v_mul_f32 v23, v23, v18
    v_fma_f32 v23, v23, s38, v18
    v_mul_f32 v23, s39, v23
    v_exp_f32 v23, v23
    s_nop 0
    v_add_f32 v23, 1.0, v23
    v_rcp_f32 v23, v23
    s_nop 0
    v_mul_f32 v18, v18, v23
    v_mul_f32 v23, v19, v19
    v_mul_f32 v23, v23, v19
    v_fma_f32 v23, v23, s38, v19
    v_mul_f32 v23, s39, v23
    v_exp_f32 v23, v23
    s_nop 0
    v_add_f32 v23, 1.0, v23
    v_rcp_f32 v23, v23
    s_nop 0
    v_mul_f32 v19, v19, v23
    v_cvt_pk_bf16_f32 v12, v18, v19
    v_lshlrev_b32 v18, 16, v13
    v_and_b32 v19, 0xffff0000, v13
    v_lshlrev_b32 v20, 16, v17
    v_and_b32 v21, 0xffff0000, v17
    v_add_f32 v18, v18, v20
    v_add_f32 v19, v19, v21
    v_cvt_pk_bf16_f32 v22, v18, v19
    v_lshlrev_b32 v18, 16, v22
    v_and_b32 v19, 0xffff0000, v22
    v_mul_f32 v23, v18, v18
    v_mul_f32 v23, v23, v18
    v_fma_f32 v23, v23, s38, v18
    v_mul_f32 v23, s39, v23
    v_exp_f32 v23, v23
    s_nop 0
    v_add_f32 v23, 1.0, v23
    v_rcp_f32 v23, v23
    s_nop 0
    v_mul_f32 v18, v18, v23
    v_mul_f32 v23, v19, v19
    v_mul_f32 v23, v23, v19
    v_fma_f32 v23, v23, s38, v19
    v_mul_f32 v23, s39, v23
    v_exp_f32 v23, v23
    s_nop 0
    v_add_f32 v23, 1.0, v23
    v_rcp_f32 v23, v23
    s_nop 0
    v_mul_f32 v19, v19, v23
    v_cvt_pk_bf16_f32 v13, v18, v19
    buffer_store_dwordx2 v[12:13], v10, s[8:11], 0 offen offset:32
    s_nop 0
    buffer_load_dwordx2 v[16:17], v11, s[12:15], 0 offen offset:48
    v_cvt_pk_bf16_f32 v12, v76, v77
    v_cvt_pk_bf16_f32 v13, v78, v79
    s_waitcnt vmcnt(0)
    v_lshlrev_b32 v18, 16, v12
    v_and_b32 v19, 0xffff0000, v12
    v_lshlrev_b32 v20, 16, v16
    v_and_b32 v21, 0xffff0000, v16
    v_add_f32 v18, v18, v20
    v_add_f32 v19, v19, v21
    v_cvt_pk_bf16_f32 v22, v18, v19
    v_lshlrev_b32 v18, 16, v22
    v_and_b32 v19, 0xffff0000, v22
    v_mul_f32 v23, v18, v18
    v_mul_f32 v23, v23, v18
    v_fma_f32 v23, v23, s38, v18
    v_mul_f32 v23, s39, v23
    v_exp_f32 v23, v23
    s_nop 0
    v_add_f32 v23, 1.0, v23
    v_rcp_f32 v23, v23
    s_nop 0
    v_mul_f32 v18, v18, v23
    v_mul_f32 v23, v19, v19
    v_mul_f32 v23, v23, v19
    v_fma_f32 v23, v23, s38, v19
    v_mul_f32 v23, s39, v23
    v_exp_f32 v23, v23
    s_nop 0
    v_add_f32 v23, 1.0, v23
    v_rcp_f32 v23, v23
    s_nop 0
    v_mul_f32 v19, v19, v23
    v_cvt_pk_bf16_f32 v12, v18, v19
    v_lshlrev_b32 v18, 16, v13
    v_and_b32 v19, 0xffff0000, v13
    v_lshlrev_b32 v20, 16, v17
    v_and_b32 v21, 0xffff0000, v17
    v_add_f32 v18, v18, v20
    v_add_f32 v19, v19, v21
    v_cvt_pk_bf16_f32 v22, v18, v19
    v_lshlrev_b32 v18, 16, v22
    v_and_b32 v19, 0xffff0000, v22
    v_mul_f32 v23, v18, v18
    v_mul_f32 v23, v23, v18
    v_fma_f32 v23, v23, s38, v18
    v_mul_f32 v23, s39, v23
    v_exp_f32 v23, v23
    s_nop 0
    v_add_f32 v23, 1.0, v23
    v_rcp_f32 v23, v23
    s_nop 0
    v_mul_f32 v18, v18, v23
    v_mul_f32 v23, v19, v19
    v_mul_f32 v23, v23, v19
    v_fma_f32 v23, v23, s38, v19
    v_mul_f32 v23, s39, v23
    v_exp_f32 v23, v23
    s_nop 0
    v_add_f32 v23, 1.0, v23
    v_rcp_f32 v23, v23
    s_nop 0
    v_mul_f32 v19, v19, v23
    v_cvt_pk_bf16_f32 v13, v18, v19
    buffer_store_dwordx2 v[12:13], v10, s[8:11], 0 offen offset:48
    s_nop 0
    buffer_load_dwordx2 v[16:17], v11, s[12:15], 0 offen offset:64
    v_cvt_pk_bf16_f32 v12, v80, v81
    v_cvt_pk_bf16_f32 v13, v82, v83
    s_waitcnt vmcnt(0)
    v_lshlrev_b32 v18, 16, v12
    v_and_b32 v19, 0xffff0000, v12
    v_lshlrev_b32 v20, 16, v16
    v_and_b32 v21, 0xffff0000, v16
    v_add_f32 v18, v18, v20
    v_add_f32 v19, v19, v21
    v_cvt_pk_bf16_f32 v22, v18, v19
    v_lshlrev_b32 v18, 16, v22
    v_and_b32 v19, 0xffff0000, v22
    v_mul_f32 v23, v18, v18
    v_mul_f32 v23, v23, v18
    v_fma_f32 v23, v23, s38, v18
    v_mul_f32 v23, s39, v23
    v_exp_f32 v23, v23
    s_nop 0
    v_add_f32 v23, 1.0, v23
    v_rcp_f32 v23, v23
    s_nop 0
    v_mul_f32 v18, v18, v23
    v_mul_f32 v23, v19, v19
    v_mul_f32 v23, v23, v19
    v_fma_f32 v23, v23, s38, v19
    v_mul_f32 v23, s39, v23
    v_exp_f32 v23, v23
    s_nop 0
    v_add_f32 v23, 1.0, v23
    v_rcp_f32 v23, v23
    s_nop 0
    v_mul_f32 v19, v19, v23
    v_cvt_pk_bf16_f32 v12, v18, v19
    v_lshlrev_b32 v18, 16, v13
    v_and_b32 v19, 0xffff0000, v13
    v_lshlrev_b32 v20, 16, v17
    v_and_b32 v21, 0xffff0000, v17
    v_add_f32 v18, v18, v20
    v_add_f32 v19, v19, v21
    v_cvt_pk_bf16_f32 v22, v18, v19
    v_lshlrev_b32 v18, 16, v22
    v_and_b32 v19, 0xffff0000, v22
    v_mul_f32 v23, v18, v18
    v_mul_f32 v23, v23, v18
    v_fma_f32 v23, v23, s38, v18
    v_mul_f32 v23, s39, v23
    v_exp_f32 v23, v23
    s_nop 0
    v_add_f32 v23, 1.0, v23
    v_rcp_f32 v23, v23
    s_nop 0
    v_mul_f32 v18, v18, v23
    v_mul_f32 v23, v19, v19
    v_mul_f32 v23, v23, v19
    v_fma_f32 v23, v23, s38, v19
    v_mul_f32 v23, s39, v23
    v_exp_f32 v23, v23
    s_nop 0
    v_add_f32 v23, 1.0, v23
    v_rcp_f32 v23, v23
    s_nop 0
    v_mul_f32 v19, v19, v23
    v_cvt_pk_bf16_f32 v13, v18, v19
    buffer_store_dwordx2 v[12:13], v10, s[8:11], 0 offen offset:64
    s_nop 0
    buffer_load_dwordx2 v[16:17], v11, s[12:15], 0 offen offset:80
    v_cvt_pk_bf16_f32 v12, v84, v85
    v_cvt_pk_bf16_f32 v13, v86, v87
    s_waitcnt vmcnt(0)
    v_lshlrev_b32 v18, 16, v12
    v_and_b32 v19, 0xffff0000, v12
    v_lshlrev_b32 v20, 16, v16
    v_and_b32 v21, 0xffff0000, v16
    v_add_f32 v18, v18, v20
    v_add_f32 v19, v19, v21
    v_cvt_pk_bf16_f32 v22, v18, v19
    v_lshlrev_b32 v18, 16, v22
    v_and_b32 v19, 0xffff0000, v22
    v_mul_f32 v23, v18, v18
    v_mul_f32 v23, v23, v18
    v_fma_f32 v23, v23, s38, v18
    v_mul_f32 v23, s39, v23
    v_exp_f32 v23, v23
    s_nop 0
    v_add_f32 v23, 1.0, v23
    v_rcp_f32 v23, v23
    s_nop 0
    v_mul_f32 v18, v18, v23
    v_mul_f32 v23, v19, v19
    v_mul_f32 v23, v23, v19
    v_fma_f32 v23, v23, s38, v19
    v_mul_f32 v23, s39, v23
    v_exp_f32 v23, v23
    s_nop 0
    v_add_f32 v23, 1.0, v23
    v_rcp_f32 v23, v23
    s_nop 0
    v_mul_f32 v19, v19, v23
    v_cvt_pk_bf16_f32 v12, v18, v19
    v_lshlrev_b32 v18, 16, v13
    v_and_b32 v19, 0xffff0000, v13
    v_lshlrev_b32 v20, 16, v17
    v_and_b32 v21, 0xffff0000, v17
    v_add_f32 v18, v18, v20
    v_add_f32 v19, v19, v21
    v_cvt_pk_bf16_f32 v22, v18, v19
    v_lshlrev_b32 v18, 16, v22
    v_and_b32 v19, 0xffff0000, v22
    v_mul_f32 v23, v18, v18
    v_mul_f32 v23, v23, v18
    v_fma_f32 v23, v23, s38, v18
    v_mul_f32 v23, s39, v23
    v_exp_f32 v23, v23
    s_nop 0
    v_add_f32 v23, 1.0, v23
    v_rcp_f32 v23, v23
    s_nop 0
    v_mul_f32 v18, v18, v23
    v_mul_f32 v23, v19, v19
    v_mul_f32 v23, v23, v19
    v_fma_f32 v23, v23, s38, v19
    v_mul_f32 v23, s39, v23
    v_exp_f32 v23, v23
    s_nop 0
    v_add_f32 v23, 1.0, v23
    v_rcp_f32 v23, v23
    s_nop 0
    v_mul_f32 v19, v19, v23
    v_cvt_pk_bf16_f32 v13, v18, v19
    buffer_store_dwordx2 v[12:13], v10, s[8:11], 0 offen offset:80
    s_nop 0
    buffer_load_dwordx2 v[16:17], v11, s[12:15], 0 offen offset:96
    v_cvt_pk_bf16_f32 v12, v88, v89
    v_cvt_pk_bf16_f32 v13, v90, v91
    s_waitcnt vmcnt(0)
    v_lshlrev_b32 v18, 16, v12
    v_and_b32 v19, 0xffff0000, v12
    v_lshlrev_b32 v20, 16, v16
    v_and_b32 v21, 0xffff0000, v16
    v_add_f32 v18, v18, v20
    v_add_f32 v19, v19, v21
    v_cvt_pk_bf16_f32 v22, v18, v19
    v_lshlrev_b32 v18, 16, v22
    v_and_b32 v19, 0xffff0000, v22
    v_mul_f32 v23, v18, v18
    v_mul_f32 v23, v23, v18
    v_fma_f32 v23, v23, s38, v18
    v_mul_f32 v23, s39, v23
    v_exp_f32 v23, v23
    s_nop 0
    v_add_f32 v23, 1.0, v23
    v_rcp_f32 v23, v23
    s_nop 0
    v_mul_f32 v18, v18, v23
    v_mul_f32 v23, v19, v19
    v_mul_f32 v23, v23, v19
    v_fma_f32 v23, v23, s38, v19
    v_mul_f32 v23, s39, v23
    v_exp_f32 v23, v23
    s_nop 0
    v_add_f32 v23, 1.0, v23
    v_rcp_f32 v23, v23
    s_nop 0
    v_mul_f32 v19, v19, v23
    v_cvt_pk_bf16_f32 v12, v18, v19
    v_lshlrev_b32 v18, 16, v13
    v_and_b32 v19, 0xffff0000, v13
    v_lshlrev_b32 v20, 16, v17
    v_and_b32 v21, 0xffff0000, v17
    v_add_f32 v18, v18, v20
    v_add_f32 v19, v19, v21
    v_cvt_pk_bf16_f32 v22, v18, v19
    v_lshlrev_b32 v18, 16, v22
    v_and_b32 v19, 0xffff0000, v22
    v_mul_f32 v23, v18, v18
    v_mul_f32 v23, v23, v18
    v_fma_f32 v23, v23, s38, v18
    v_mul_f32 v23, s39, v23
    v_exp_f32 v23, v23
    s_nop 0
    v_add_f32 v23, 1.0, v23
    v_rcp_f32 v23, v23
    s_nop 0
    v_mul_f32 v18, v18, v23
    v_mul_f32 v23, v19, v19
    v_mul_f32 v23, v23, v19
    v_fma_f32 v23, v23, s38, v19
    v_mul_f32 v23, s39, v23
    v_exp_f32 v23, v23
    s_nop 0
    v_add_f32 v23, 1.0, v23
    v_rcp_f32 v23, v23
    s_nop 0
    v_mul_f32 v19, v19, v23
    v_cvt_pk_bf16_f32 v13, v18, v19
    buffer_store_dwordx2 v[12:13], v10, s[8:11], 0 offen offset:96
    s_nop 0
    buffer_load_dwordx2 v[16:17], v11, s[12:15], 0 offen offset:112
    v_cvt_pk_bf16_f32 v12, v92, v93
    v_cvt_pk_bf16_f32 v13, v94, v95
    s_waitcnt vmcnt(0)
    v_lshlrev_b32 v18, 16, v12
    v_and_b32 v19, 0xffff0000, v12
    v_lshlrev_b32 v20, 16, v16
    v_and_b32 v21, 0xffff0000, v16
    v_add_f32 v18, v18, v20
    v_add_f32 v19, v19, v21
    v_cvt_pk_bf16_f32 v22, v18, v19
    v_lshlrev_b32 v18, 16, v22
    v_and_b32 v19, 0xffff0000, v22
    v_mul_f32 v23, v18, v18
    v_mul_f32 v23, v23, v18
    v_fma_f32 v23, v23, s38, v18
    v_mul_f32 v23, s39, v23
    v_exp_f32 v23, v23
    s_nop 0
    v_add_f32 v23, 1.0, v23
    v_rcp_f32 v23, v23
    s_nop 0
    v_mul_f32 v18, v18, v23
    v_mul_f32 v23, v19, v19
    v_mul_f32 v23, v23, v19
    v_fma_f32 v23, v23, s38, v19
    v_mul_f32 v23, s39, v23
    v_exp_f32 v23, v23
    s_nop 0
    v_add_f32 v23, 1.0, v23
    v_rcp_f32 v23, v23
    s_nop 0
    v_mul_f32 v19, v19, v23
    v_cvt_pk_bf16_f32 v12, v18, v19
    v_lshlrev_b32 v18, 16, v13
    v_and_b32 v19, 0xffff0000, v13
    v_lshlrev_b32 v20, 16, v17
    v_and_b32 v21, 0xffff0000, v17
    v_add_f32 v18, v18, v20
    v_add_f32 v19, v19, v21
    v_cvt_pk_bf16_f32 v22, v18, v19
    v_lshlrev_b32 v18, 16, v22
    v_and_b32 v19, 0xffff0000, v22
    v_mul_f32 v23, v18, v18
    v_mul_f32 v23, v23, v18
    v_fma_f32 v23, v23, s38, v18
    v_mul_f32 v23, s39, v23
    v_exp_f32 v23, v23
    s_nop 0
    v_add_f32 v23, 1.0, v23
    v_rcp_f32 v23, v23
    s_nop 0
    v_mul_f32 v18, v18, v23
    v_mul_f32 v23, v19, v19
    v_mul_f32 v23, v23, v19
    v_fma_f32 v23, v23, s38, v19
    v_mul_f32 v23, s39, v23
    v_exp_f32 v23, v23
    s_nop 0
    v_add_f32 v23, 1.0, v23
    v_rcp_f32 v23, v23
    s_nop 0
    v_mul_f32 v19, v19, v23
    v_cvt_pk_bf16_f32 v13, v18, v19
    buffer_store_dwordx2 v[12:13], v10, s[8:11], 0 offen offset:112
    s_nop 0
    v_add_u32 v10, 98304, v10
    buffer_load_dwordx2 v[16:17], v11, s[12:15], 0 offen offset:0
    v_cvt_pk_bf16_f32 v12, v96, v97
    v_cvt_pk_bf16_f32 v13, v98, v99
    s_waitcnt vmcnt(0)
    v_lshlrev_b32 v18, 16, v12
    v_and_b32 v19, 0xffff0000, v12
    v_lshlrev_b32 v20, 16, v16
    v_and_b32 v21, 0xffff0000, v16
    v_add_f32 v18, v18, v20
    v_add_f32 v19, v19, v21
    v_cvt_pk_bf16_f32 v22, v18, v19
    v_lshlrev_b32 v18, 16, v22
    v_and_b32 v19, 0xffff0000, v22
    v_mul_f32 v23, v18, v18
    v_mul_f32 v23, v23, v18
    v_fma_f32 v23, v23, s38, v18
    v_mul_f32 v23, s39, v23
    v_exp_f32 v23, v23
    s_nop 0
    v_add_f32 v23, 1.0, v23
    v_rcp_f32 v23, v23
    s_nop 0
    v_mul_f32 v18, v18, v23
    v_mul_f32 v23, v19, v19
    v_mul_f32 v23, v23, v19
    v_fma_f32 v23, v23, s38, v19
    v_mul_f32 v23, s39, v23
    v_exp_f32 v23, v23
    s_nop 0
    v_add_f32 v23, 1.0, v23
    v_rcp_f32 v23, v23
    s_nop 0
    v_mul_f32 v19, v19, v23
    v_cvt_pk_bf16_f32 v12, v18, v19
    v_lshlrev_b32 v18, 16, v13
    v_and_b32 v19, 0xffff0000, v13
    v_lshlrev_b32 v20, 16, v17
    v_and_b32 v21, 0xffff0000, v17
    v_add_f32 v18, v18, v20
    v_add_f32 v19, v19, v21
    v_cvt_pk_bf16_f32 v22, v18, v19
    v_lshlrev_b32 v18, 16, v22
    v_and_b32 v19, 0xffff0000, v22
    v_mul_f32 v23, v18, v18
    v_mul_f32 v23, v23, v18
    v_fma_f32 v23, v23, s38, v18
    v_mul_f32 v23, s39, v23
    v_exp_f32 v23, v23
    s_nop 0
    v_add_f32 v23, 1.0, v23
    v_rcp_f32 v23, v23
    s_nop 0
    v_mul_f32 v18, v18, v23
    v_mul_f32 v23, v19, v19
    v_mul_f32 v23, v23, v19
    v_fma_f32 v23, v23, s38, v19
    v_mul_f32 v23, s39, v23
    v_exp_f32 v23, v23
    s_nop 0
    v_add_f32 v23, 1.0, v23
    v_rcp_f32 v23, v23
    s_nop 0
    v_mul_f32 v19, v19, v23
    v_cvt_pk_bf16_f32 v13, v18, v19
    buffer_store_dwordx2 v[12:13], v10, s[8:11], 0 offen offset:0
    s_nop 0
    buffer_load_dwordx2 v[16:17], v11, s[12:15], 0 offen offset:16
    v_cvt_pk_bf16_f32 v12, v100, v101
    v_cvt_pk_bf16_f32 v13, v102, v103
    s_waitcnt vmcnt(0)
    v_lshlrev_b32 v18, 16, v12
    v_and_b32 v19, 0xffff0000, v12
    v_lshlrev_b32 v20, 16, v16
    v_and_b32 v21, 0xffff0000, v16
    v_add_f32 v18, v18, v20
    v_add_f32 v19, v19, v21
    v_cvt_pk_bf16_f32 v22, v18, v19
    v_lshlrev_b32 v18, 16, v22
    v_and_b32 v19, 0xffff0000, v22
    v_mul_f32 v23, v18, v18
    v_mul_f32 v23, v23, v18
    v_fma_f32 v23, v23, s38, v18
    v_mul_f32 v23, s39, v23
    v_exp_f32 v23, v23
    s_nop 0
    v_add_f32 v23, 1.0, v23
    v_rcp_f32 v23, v23
    s_nop 0
    v_mul_f32 v18, v18, v23
    v_mul_f32 v23, v19, v19
    v_mul_f32 v23, v23, v19
    v_fma_f32 v23, v23, s38, v19
    v_mul_f32 v23, s39, v23
    v_exp_f32 v23, v23
    s_nop 0
    v_add_f32 v23, 1.0, v23
    v_rcp_f32 v23, v23
    s_nop 0
    v_mul_f32 v19, v19, v23
    v_cvt_pk_bf16_f32 v12, v18, v19
    v_lshlrev_b32 v18, 16, v13
    v_and_b32 v19, 0xffff0000, v13
    v_lshlrev_b32 v20, 16, v17
    v_and_b32 v21, 0xffff0000, v17
    v_add_f32 v18, v18, v20
    v_add_f32 v19, v19, v21
    v_cvt_pk_bf16_f32 v22, v18, v19
    v_lshlrev_b32 v18, 16, v22
    v_and_b32 v19, 0xffff0000, v22
    v_mul_f32 v23, v18, v18
    v_mul_f32 v23, v23, v18
    v_fma_f32 v23, v23, s38, v18
    v_mul_f32 v23, s39, v23
    v_exp_f32 v23, v23
    s_nop 0
    v_add_f32 v23, 1.0, v23
    v_rcp_f32 v23, v23
    s_nop 0
    v_mul_f32 v18, v18, v23
    v_mul_f32 v23, v19, v19
    v_mul_f32 v23, v23, v19
    v_fma_f32 v23, v23, s38, v19
    v_mul_f32 v23, s39, v23
    v_exp_f32 v23, v23
    s_nop 0
    v_add_f32 v23, 1.0, v23
    v_rcp_f32 v23, v23
    s_nop 0
    v_mul_f32 v19, v19, v23
    v_cvt_pk_bf16_f32 v13, v18, v19
    buffer_store_dwordx2 v[12:13], v10, s[8:11], 0 offen offset:16
    s_nop 0
    buffer_load_dwordx2 v[16:17], v11, s[12:15], 0 offen offset:32
    v_cvt_pk_bf16_f32 v12, v104, v105
    v_cvt_pk_bf16_f32 v13, v106, v107
    s_waitcnt vmcnt(0)
    v_lshlrev_b32 v18, 16, v12
    v_and_b32 v19, 0xffff0000, v12
    v_lshlrev_b32 v20, 16, v16
    v_and_b32 v21, 0xffff0000, v16
    v_add_f32 v18, v18, v20
    v_add_f32 v19, v19, v21
    v_cvt_pk_bf16_f32 v22, v18, v19
    v_lshlrev_b32 v18, 16, v22
    v_and_b32 v19, 0xffff0000, v22
    v_mul_f32 v23, v18, v18
    v_mul_f32 v23, v23, v18
    v_fma_f32 v23, v23, s38, v18
    v_mul_f32 v23, s39, v23
    v_exp_f32 v23, v23
    s_nop 0
    v_add_f32 v23, 1.0, v23
    v_rcp_f32 v23, v23
    s_nop 0
    v_mul_f32 v18, v18, v23
    v_mul_f32 v23, v19, v19
    v_mul_f32 v23, v23, v19
    v_fma_f32 v23, v23, s38, v19
    v_mul_f32 v23, s39, v23
    v_exp_f32 v23, v23
    s_nop 0
    v_add_f32 v23, 1.0, v23
    v_rcp_f32 v23, v23
    s_nop 0
    v_mul_f32 v19, v19, v23
    v_cvt_pk_bf16_f32 v12, v18, v19
    v_lshlrev_b32 v18, 16, v13
    v_and_b32 v19, 0xffff0000, v13
    v_lshlrev_b32 v20, 16, v17
    v_and_b32 v21, 0xffff0000, v17
    v_add_f32 v18, v18, v20
    v_add_f32 v19, v19, v21
    v_cvt_pk_bf16_f32 v22, v18, v19
    v_lshlrev_b32 v18, 16, v22
    v_and_b32 v19, 0xffff0000, v22
    v_mul_f32 v23, v18, v18
    v_mul_f32 v23, v23, v18
    v_fma_f32 v23, v23, s38, v18
    v_mul_f32 v23, s39, v23
    v_exp_f32 v23, v23
    s_nop 0
    v_add_f32 v23, 1.0, v23
    v_rcp_f32 v23, v23
    s_nop 0
    v_mul_f32 v18, v18, v23
    v_mul_f32 v23, v19, v19
    v_mul_f32 v23, v23, v19
    v_fma_f32 v23, v23, s38, v19
    v_mul_f32 v23, s39, v23
    v_exp_f32 v23, v23
    s_nop 0
    v_add_f32 v23, 1.0, v23
    v_rcp_f32 v23, v23
    s_nop 0
    v_mul_f32 v19, v19, v23
    v_cvt_pk_bf16_f32 v13, v18, v19
    buffer_store_dwordx2 v[12:13], v10, s[8:11], 0 offen offset:32
    s_nop 0
    buffer_load_dwordx2 v[16:17], v11, s[12:15], 0 offen offset:48
    v_cvt_pk_bf16_f32 v12, v108, v109
    v_cvt_pk_bf16_f32 v13, v110, v111
    s_waitcnt vmcnt(0)
    v_lshlrev_b32 v18, 16, v12
    v_and_b32 v19, 0xffff0000, v12
    v_lshlrev_b32 v20, 16, v16
    v_and_b32 v21, 0xffff0000, v16
    v_add_f32 v18, v18, v20
    v_add_f32 v19, v19, v21
    v_cvt_pk_bf16_f32 v22, v18, v19
    v_lshlrev_b32 v18, 16, v22
    v_and_b32 v19, 0xffff0000, v22
    v_mul_f32 v23, v18, v18
    v_mul_f32 v23, v23, v18
    v_fma_f32 v23, v23, s38, v18
    v_mul_f32 v23, s39, v23
    v_exp_f32 v23, v23
    s_nop 0
    v_add_f32 v23, 1.0, v23
    v_rcp_f32 v23, v23
    s_nop 0
    v_mul_f32 v18, v18, v23
    v_mul_f32 v23, v19, v19
    v_mul_f32 v23, v23, v19
    v_fma_f32 v23, v23, s38, v19
    v_mul_f32 v23, s39, v23
    v_exp_f32 v23, v23
    s_nop 0
    v_add_f32 v23, 1.0, v23
    v_rcp_f32 v23, v23
    s_nop 0
    v_mul_f32 v19, v19, v23
    v_cvt_pk_bf16_f32 v12, v18, v19
    v_lshlrev_b32 v18, 16, v13
    v_and_b32 v19, 0xffff0000, v13
    v_lshlrev_b32 v20, 16, v17
    v_and_b32 v21, 0xffff0000, v17
    v_add_f32 v18, v18, v20
    v_add_f32 v19, v19, v21
    v_cvt_pk_bf16_f32 v22, v18, v19
    v_lshlrev_b32 v18, 16, v22
    v_and_b32 v19, 0xffff0000, v22
    v_mul_f32 v23, v18, v18
    v_mul_f32 v23, v23, v18
    v_fma_f32 v23, v23, s38, v18
    v_mul_f32 v23, s39, v23
    v_exp_f32 v23, v23
    s_nop 0
    v_add_f32 v23, 1.0, v23
    v_rcp_f32 v23, v23
    s_nop 0
    v_mul_f32 v18, v18, v23
    v_mul_f32 v23, v19, v19
    v_mul_f32 v23, v23, v19
    v_fma_f32 v23, v23, s38, v19
    v_mul_f32 v23, s39, v23
    v_exp_f32 v23, v23
    s_nop 0
    v_add_f32 v23, 1.0, v23
    v_rcp_f32 v23, v23
    s_nop 0
    v_mul_f32 v19, v19, v23
    v_cvt_pk_bf16_f32 v13, v18, v19
    buffer_store_dwordx2 v[12:13], v10, s[8:11], 0 offen offset:48
    s_nop 0
    buffer_load_dwordx2 v[16:17], v11, s[12:15], 0 offen offset:64
    v_cvt_pk_bf16_f32 v12, v112, v113
    v_cvt_pk_bf16_f32 v13, v114, v115
    s_waitcnt vmcnt(0)
    v_lshlrev_b32 v18, 16, v12
    v_and_b32 v19, 0xffff0000, v12
    v_lshlrev_b32 v20, 16, v16
    v_and_b32 v21, 0xffff0000, v16
    v_add_f32 v18, v18, v20
    v_add_f32 v19, v19, v21
    v_cvt_pk_bf16_f32 v22, v18, v19
    v_lshlrev_b32 v18, 16, v22
    v_and_b32 v19, 0xffff0000, v22
    v_mul_f32 v23, v18, v18
    v_mul_f32 v23, v23, v18
    v_fma_f32 v23, v23, s38, v18
    v_mul_f32 v23, s39, v23
    v_exp_f32 v23, v23
    s_nop 0
    v_add_f32 v23, 1.0, v23
    v_rcp_f32 v23, v23
    s_nop 0
    v_mul_f32 v18, v18, v23
    v_mul_f32 v23, v19, v19
    v_mul_f32 v23, v23, v19
    v_fma_f32 v23, v23, s38, v19
    v_mul_f32 v23, s39, v23
    v_exp_f32 v23, v23
    s_nop 0
    v_add_f32 v23, 1.0, v23
    v_rcp_f32 v23, v23
    s_nop 0
    v_mul_f32 v19, v19, v23
    v_cvt_pk_bf16_f32 v12, v18, v19
    v_lshlrev_b32 v18, 16, v13
    v_and_b32 v19, 0xffff0000, v13
    v_lshlrev_b32 v20, 16, v17
    v_and_b32 v21, 0xffff0000, v17
    v_add_f32 v18, v18, v20
    v_add_f32 v19, v19, v21
    v_cvt_pk_bf16_f32 v22, v18, v19
    v_lshlrev_b32 v18, 16, v22
    v_and_b32 v19, 0xffff0000, v22
    v_mul_f32 v23, v18, v18
    v_mul_f32 v23, v23, v18
    v_fma_f32 v23, v23, s38, v18
    v_mul_f32 v23, s39, v23
    v_exp_f32 v23, v23
    s_nop 0
    v_add_f32 v23, 1.0, v23
    v_rcp_f32 v23, v23
    s_nop 0
    v_mul_f32 v18, v18, v23
    v_mul_f32 v23, v19, v19
    v_mul_f32 v23, v23, v19
    v_fma_f32 v23, v23, s38, v19
    v_mul_f32 v23, s39, v23
    v_exp_f32 v23, v23
    s_nop 0
    v_add_f32 v23, 1.0, v23
    v_rcp_f32 v23, v23
    s_nop 0
    v_mul_f32 v19, v19, v23
    v_cvt_pk_bf16_f32 v13, v18, v19
    buffer_store_dwordx2 v[12:13], v10, s[8:11], 0 offen offset:64
    s_nop 0
    buffer_load_dwordx2 v[16:17], v11, s[12:15], 0 offen offset:80
    v_cvt_pk_bf16_f32 v12, v116, v117
    v_cvt_pk_bf16_f32 v13, v118, v119
    s_waitcnt vmcnt(0)
    v_lshlrev_b32 v18, 16, v12
    v_and_b32 v19, 0xffff0000, v12
    v_lshlrev_b32 v20, 16, v16
    v_and_b32 v21, 0xffff0000, v16
    v_add_f32 v18, v18, v20
    v_add_f32 v19, v19, v21
    v_cvt_pk_bf16_f32 v22, v18, v19
    v_lshlrev_b32 v18, 16, v22
    v_and_b32 v19, 0xffff0000, v22
    v_mul_f32 v23, v18, v18
    v_mul_f32 v23, v23, v18
    v_fma_f32 v23, v23, s38, v18
    v_mul_f32 v23, s39, v23
    v_exp_f32 v23, v23
    s_nop 0
    v_add_f32 v23, 1.0, v23
    v_rcp_f32 v23, v23
    s_nop 0
    v_mul_f32 v18, v18, v23
    v_mul_f32 v23, v19, v19
    v_mul_f32 v23, v23, v19
    v_fma_f32 v23, v23, s38, v19
    v_mul_f32 v23, s39, v23
    v_exp_f32 v23, v23
    s_nop 0
    v_add_f32 v23, 1.0, v23
    v_rcp_f32 v23, v23
    s_nop 0
    v_mul_f32 v19, v19, v23
    v_cvt_pk_bf16_f32 v12, v18, v19
    v_lshlrev_b32 v18, 16, v13
    v_and_b32 v19, 0xffff0000, v13
    v_lshlrev_b32 v20, 16, v17
    v_and_b32 v21, 0xffff0000, v17
    v_add_f32 v18, v18, v20
    v_add_f32 v19, v19, v21
    v_cvt_pk_bf16_f32 v22, v18, v19
    v_lshlrev_b32 v18, 16, v22
    v_and_b32 v19, 0xffff0000, v22
    v_mul_f32 v23, v18, v18
    v_mul_f32 v23, v23, v18
    v_fma_f32 v23, v23, s38, v18
    v_mul_f32 v23, s39, v23
    v_exp_f32 v23, v23
    s_nop 0
    v_add_f32 v23, 1.0, v23
    v_rcp_f32 v23, v23
    s_nop 0
    v_mul_f32 v18, v18, v23
    v_mul_f32 v23, v19, v19
    v_mul_f32 v23, v23, v19
    v_fma_f32 v23, v23, s38, v19
    v_mul_f32 v23, s39, v23
    v_exp_f32 v23, v23
    s_nop 0
    v_add_f32 v23, 1.0, v23
    v_rcp_f32 v23, v23
    s_nop 0
    v_mul_f32 v19, v19, v23
    v_cvt_pk_bf16_f32 v13, v18, v19
    buffer_store_dwordx2 v[12:13], v10, s[8:11], 0 offen offset:80
    s_nop 0
    buffer_load_dwordx2 v[16:17], v11, s[12:15], 0 offen offset:96
    v_cvt_pk_bf16_f32 v12, v120, v121
    v_cvt_pk_bf16_f32 v13, v122, v123
    s_waitcnt vmcnt(0)
    v_lshlrev_b32 v18, 16, v12
    v_and_b32 v19, 0xffff0000, v12
    v_lshlrev_b32 v20, 16, v16
    v_and_b32 v21, 0xffff0000, v16
    v_add_f32 v18, v18, v20
    v_add_f32 v19, v19, v21
    v_cvt_pk_bf16_f32 v22, v18, v19
    v_lshlrev_b32 v18, 16, v22
    v_and_b32 v19, 0xffff0000, v22
    v_mul_f32 v23, v18, v18
    v_mul_f32 v23, v23, v18
    v_fma_f32 v23, v23, s38, v18
    v_mul_f32 v23, s39, v23
    v_exp_f32 v23, v23
    s_nop 0
    v_add_f32 v23, 1.0, v23
    v_rcp_f32 v23, v23
    s_nop 0
    v_mul_f32 v18, v18, v23
    v_mul_f32 v23, v19, v19
    v_mul_f32 v23, v23, v19
    v_fma_f32 v23, v23, s38, v19
    v_mul_f32 v23, s39, v23
    v_exp_f32 v23, v23
    s_nop 0
    v_add_f32 v23, 1.0, v23
    v_rcp_f32 v23, v23
    s_nop 0
    v_mul_f32 v19, v19, v23
    v_cvt_pk_bf16_f32 v12, v18, v19
    v_lshlrev_b32 v18, 16, v13
    v_and_b32 v19, 0xffff0000, v13
    v_lshlrev_b32 v20, 16, v17
    v_and_b32 v21, 0xffff0000, v17
    v_add_f32 v18, v18, v20
    v_add_f32 v19, v19, v21
    v_cvt_pk_bf16_f32 v22, v18, v19
    v_lshlrev_b32 v18, 16, v22
    v_and_b32 v19, 0xffff0000, v22
    v_mul_f32 v23, v18, v18
    v_mul_f32 v23, v23, v18
    v_fma_f32 v23, v23, s38, v18
    v_mul_f32 v23, s39, v23
    v_exp_f32 v23, v23
    s_nop 0
    v_add_f32 v23, 1.0, v23
    v_rcp_f32 v23, v23
    s_nop 0
    v_mul_f32 v18, v18, v23
    v_mul_f32 v23, v19, v19
    v_mul_f32 v23, v23, v19
    v_fma_f32 v23, v23, s38, v19
    v_mul_f32 v23, s39, v23
    v_exp_f32 v23, v23
    s_nop 0
    v_add_f32 v23, 1.0, v23
    v_rcp_f32 v23, v23
    s_nop 0
    v_mul_f32 v19, v19, v23
    v_cvt_pk_bf16_f32 v13, v18, v19
    buffer_store_dwordx2 v[12:13], v10, s[8:11], 0 offen offset:96
    s_nop 0
    buffer_load_dwordx2 v[16:17], v11, s[12:15], 0 offen offset:112
    v_cvt_pk_bf16_f32 v12, v124, v125
    v_cvt_pk_bf16_f32 v13, v126, v127
    s_waitcnt vmcnt(0)
    v_lshlrev_b32 v18, 16, v12
    v_and_b32 v19, 0xffff0000, v12
    v_lshlrev_b32 v20, 16, v16
    v_and_b32 v21, 0xffff0000, v16
    v_add_f32 v18, v18, v20
    v_add_f32 v19, v19, v21
    v_cvt_pk_bf16_f32 v22, v18, v19
    v_lshlrev_b32 v18, 16, v22
    v_and_b32 v19, 0xffff0000, v22
    v_mul_f32 v23, v18, v18
    v_mul_f32 v23, v23, v18
    v_fma_f32 v23, v23, s38, v18
    v_mul_f32 v23, s39, v23
    v_exp_f32 v23, v23
    s_nop 0
    v_add_f32 v23, 1.0, v23
    v_rcp_f32 v23, v23
    s_nop 0
    v_mul_f32 v18, v18, v23
    v_mul_f32 v23, v19, v19
    v_mul_f32 v23, v23, v19
    v_fma_f32 v23, v23, s38, v19
    v_mul_f32 v23, s39, v23
    v_exp_f32 v23, v23
    s_nop 0
    v_add_f32 v23, 1.0, v23
    v_rcp_f32 v23, v23
    s_nop 0
    v_mul_f32 v19, v19, v23
    v_cvt_pk_bf16_f32 v12, v18, v19
    v_lshlrev_b32 v18, 16, v13
    v_and_b32 v19, 0xffff0000, v13
    v_lshlrev_b32 v20, 16, v17
    v_and_b32 v21, 0xffff0000, v17
    v_add_f32 v18, v18, v20
    v_add_f32 v19, v19, v21
    v_cvt_pk_bf16_f32 v22, v18, v19
    v_lshlrev_b32 v18, 16, v22
    v_and_b32 v19, 0xffff0000, v22
    v_mul_f32 v23, v18, v18
    v_mul_f32 v23, v23, v18
    v_fma_f32 v23, v23, s38, v18
    v_mul_f32 v23, s39, v23
    v_exp_f32 v23, v23
    s_nop 0
    v_add_f32 v23, 1.0, v23
    v_rcp_f32 v23, v23
    s_nop 0
    v_mul_f32 v18, v18, v23
    v_mul_f32 v23, v19, v19
    v_mul_f32 v23, v23, v19
    v_fma_f32 v23, v23, s38, v19
    v_mul_f32 v23, s39, v23
    v_exp_f32 v23, v23
    s_nop 0
    v_add_f32 v23, 1.0, v23
    v_rcp_f32 v23, v23
    s_nop 0
    v_mul_f32 v19, v19, v23
    v_cvt_pk_bf16_f32 v13, v18, v19
    buffer_store_dwordx2 v[12:13], v10, s[8:11], 0 offen offset:112
    s_nop 0
Lm1_end:
    s_endpgm
    .globl sequential_preLN__memory_aug_recurrent_mem_tr__mixer_channel_mlp__prompt_mlp2_kernel
    .p2align 8
    .type sequential_preLN__memory_aug_recurrent_mem_tr__mixer_channel_mlp__prompt_mlp2_kernel,@function
sequential_preLN__memory_aug_recurrent_mem_tr__mixer_channel_mlp__prompt_mlp2_kernel:
    s_cmp_ge_u32 s2, 320
    s_cbranch_scc1 Lm2_end
    s_load_dwordx2 s[4:5], s[0:1], 112
    s_waitcnt lgkmcnt(0)
    s_mov_b32 s8, s4
    s_and_b32 s9, s5, 0xffff
    s_mov_b32 s10, 0x10000000
    s_mov_b32 s11, 0x00020000
    s_load_dwordx2 s[6:7], s[0:1], 88
    s_load_dwordx2 s[16:17], s[0:1], 96
    v_and_b32 v1, 63, v0
    v_lshrrev_b32 v2, 6, v0
    s_mul_hi_u32 s37, s2, 0x8000000
    s_mul_i32 s36, s37, 32
    s_sub_u32 s36, s2, s36
    s_mul_i32 s36, s36, 64
    s_mul_i32 s37, s37, 64
    v_lshrrev_b32 v3, 3, v0
    v_and_b32 v4, 7, v0
    v_add_u32 v5, s36, v3
    s_mov_b32 s38, 3072
    v_mul_lo_u32 v5, v5, s38
    v_lshl_add_u32 v5, v4, 4, v5
    v_add_u32 v48, 0xa200000, v5
    v_add_u32 v49, 98304, v48
    v_add_u32 v5, s37, v3
    s_mov_b32 s38, 3072
    v_mul_lo_u32 v5, v5, s38
    v_lshl_add_u32 v5, v4, 4, v5
    v_add_u32 v52, 0x2600000, v5
    v_add_u32 v53, 98304, v52
    v_mul_u32_u24 v58, 144, v3
    v_lshl_add_u32 v58, v4, 4, v58
    v_add_u32 v59, 9216, v58
    v_and_b32 v6, 31, v1
    v_lshrrev_b32 v7, 5, v1
    v_and_b32 v8, 1, v2
    v_lshrrev_b32 v9, 1, v2
    v_mul_u32_u24 v8, 32, v8
    v_add_u32 v8, v8, v6
    v_mul_u32_u24 v56, 144, v8
    v_lshl_add_u32 v56, v7, 4, v56
    v_mul_u32_u24 v9, 32, v9
    v_add_u32 v9, v9, v6
    v_mul_u32_u24 v57, 144, v9
    v_lshl_add_u32 v57, v7, 4, v57
    v_add_u32 v57, 9216, v57
    s_waitcnt lgkmcnt(0)
    s_mov_b32 s12, s6
    s_and_b32 s13, s7, 0xffff
    s_mov_b32 s14, 0x500
    s_mov_b32 s15, 0x00020000
    s_mov_b32 s20, s16
    s_and_b32 s21, s17, 0xffff
    s_mov_b32 s22, 0x280000
    s_mov_b32 s23, 0x00020000
    v_mov_b32 v64, 0
    v_mov_b32 v65, 0
    v_mov_b32 v66, 0
    v_mov_b32 v67, 0
    v_mov_b32 v68, 0
    v_mov_b32 v69, 0
    v_mov_b32 v70, 0
    v_mov_b32 v71, 0
    v_mov_b32 v72, 0
    v_mov_b32 v73, 0
    v_mov_b32 v74, 0
    v_mov_b32 v75, 0
    v_mov_b32 v76, 0
    v_mov_b32 v77, 0
    v_mov_b32 v78, 0
    v_mov_b32 v79, 0
    s_mov_b32 s40, 0
    buffer_load_dwordx4 v[128:131], v48, s[8:11], s40 offen
    buffer_load_dwordx4 v[132:135], v49, s[8:11], s40 offen
    buffer_load_dwordx4 v[136:139], v52, s[8:11], s40 offen
    buffer_load_dwordx4 v[140:143], v53, s[8:11], s40 offen
    s_waitcnt vmcnt(0)
    ds_write_b128 v58, v[128:131] offset:0
    ds_write_b128 v58, v[132:135] offset:4608
    ds_write_b128 v59, v[136:139] offset:0
    ds_write_b128 v59, v[140:143] offset:4608
    s_mov_b32 s40, 128
    buffer_load_dwordx4 v[128:131], v48, s[8:11], s40 offen
    buffer_load_dwordx4 v[132:135], v49, s[8:11], s40 offen
    buffer_load_dwordx4 v[136:139], v52, s[8:11], s40 offen
    buffer_load_dwordx4 v[140:143], v53, s[8:11], s40 offen
    s_waitcnt lgkmcnt(0)
    s_barrier
    s_mov_b32 s41, 0
Lg_m2_loop:
    ds_read_b128 v[168:171], v56 offset:0
    ds_read_b128 v[172:175], v57 offset:0
    ds_read_b128 v[176:179], v56 offset:32
    ds_read_b128 v[180:183], v57 offset:32
    s_waitcnt lgkmcnt(2)
    v_mfma_f32_32x32x16_bf16 v[64:79], v[172:175], v[168:171], v[64:79]
    ds_read_b128 v[168:171], v56 offset:64
    ds_read_b128 v[172:175], v57 offset:64
    s_waitcnt lgkmcnt(2)
    v_mfma_f32_32x32x16_bf16 v[64:79], v[180:183], v[176:179], v[64:79]
    ds_read_b128 v[176:179], v56 offset:96
    ds_read_b128 v[180:183], v57 offset:96
    s_waitcnt lgkmcnt(2)
    v_mfma_f32_32x32x16_bf16 v[64:79], v[172:175], v[168:171], v[64:79]
    s_waitcnt lgkmcnt(0)
    v_mfma_f32_32x32x16_bf16 v[64:79], v[180:183], v[176:179], v[64:79]
    s_waitcnt vmcnt(0)
    ds_write_b128 v58, v[128:131] offset:18432
    ds_write_b128 v58, v[132:135] offset:23040
    ds_write_b128 v59, v[136:139] offset:18432
    ds_write_b128 v59, v[140:143] offset:23040
    s_add_u32 s40, s40, 128
    buffer_load_dwordx4 v[128:131], v48, s[8:11], s40 offen
    buffer_load_dwordx4 v[132:135], v49, s[8:11], s40 offen
    buffer_load_dwordx4 v[136:139], v52, s[8:11], s40 offen
    buffer_load_dwordx4 v[140:143], v53, s[8:11], s40 offen
    s_waitcnt lgkmcnt(0)
    s_barrier
    ds_read_b128 v[168:171], v56 offset:18432
    ds_read_b128 v[172:175], v57 offset:18432
    ds_read_b128 v[176:179], v56 offset:18464
    ds_read_b128 v[180:183], v57 offset:18464
    s_waitcnt lgkmcnt(2)
    v_mfma_f32_32x32x16_bf16 v[64:79], v[172:175], v[168:171], v[64:79]
    ds_read_b128 v[168:171], v56 offset:18496
    ds_read_b128 v[172:175], v57 offset:18496
    s_waitcnt lgkmcnt(2)
    v_mfma_f32_32x32x16_bf16 v[64:79], v[180:183], v[176:179], v[64:79]
    ds_read_b128 v[176:179], v56 offset:18528
    ds_read_b128 v[180:183], v57 offset:18528
    s_waitcnt lgkmcnt(2)
    v_mfma_f32_32x32x16_bf16 v[64:79], v[172:175], v[168:171], v[64:79]
    s_waitcnt lgkmcnt(0)
    v_mfma_f32_32x32x16_bf16 v[64:79], v[180:183], v[176:179], v[64:79]
    s_waitcnt vmcnt(0)
    ds_write_b128 v58, v[128:131] offset:0
    ds_write_b128 v58, v[132:135] offset:4608
    ds_write_b128 v59, v[136:139] offset:0
    ds_write_b128 v59, v[140:143] offset:4608
    s_add_u32 s40, s40, 128
    buffer_load_dwordx4 v[128:131], v48, s[8:11], s40 offen
    buffer_load_dwordx4 v[132:135], v49, s[8:11], s40 offen
    buffer_load_dwordx4 v[136:139], v52, s[8:11], s40 offen
    buffer_load_dwordx4 v[140:143], v53, s[8:11], s40 offen
    s_waitcnt lgkmcnt(0)
    s_barrier
    s_add_u32 s41, s41, 2
    s_cmp_lt_u32 s41, 24
    s_cbranch_scc1 Lg_m2_loop
    s_waitcnt vmcnt(0)
    s_nop 15
    s_nop 15
    v_add_u32 v10, s36, v8
    v_mul_u32_u24 v10, 1280, v10
    v_lshrrev_b32 v11, 1, v2
    v_lshlrev_b32 v11, 5, v11
    v_lshl_add_u32 v11, v7, 2, v11
    v_add_u32 v11, s37, v11
    v_lshlrev_b32 v11, 1, v11
    v_add_u32 v10, v10, v11
    v_add_u32 v14, 0x9c00000, v10
    buffer_load_dwordx2 v[16:17], v11, s[12:15], 0 offen offset:0
    buffer_load_dwordx2 v[24:25], v14, s[8:11], 0 offen offset:0
    v_cvt_pk_bf16_f32 v12, v64, v65
    v_cvt_pk_bf16_f32 v13, v66, v67
    s_waitcnt vmcnt(0)
    v_lshlrev_b32 v18, 16, v12
    v_and_b32 v19, 0xffff0000, v12
    v_lshlrev_b32 v20, 16, v16
    v_and_b32 v21, 0xffff0000, v16
    v_add_f32 v18, v18, v20
    v_add_f32 v19, v19, v21
    v_cvt_pk_bf16_f32 v22, v18, v19
    v_lshlrev_b32 v18, 16, v22
    v_and_b32 v19, 0xffff0000, v22
    v_lshlrev_b32 v20, 16, v24
    v_and_b32 v21, 0xffff0000, v24
    v_add_f32 v18, v18, v20
    v_add_f32 v19, v19, v21
    v_cvt_pk_bf16_f32 v12, v18, v19
    v_lshlrev_b32 v18, 16, v13
    v_and_b32 v19, 0xffff0000, v13
    v_lshlrev_b32 v20, 16, v17
    v_and_b32 v21, 0xffff0000, v17
    v_add_f32 v18, v18, v20
    v_add_f32 v19, v19, v21
    v_cvt_pk_bf16_f32 v22, v18, v19
    v_lshlrev_b32 v18, 16, v22
    v_and_b32 v19, 0xffff0000, v22
    v_lshlrev_b32 v20, 16, v25
    v_and_b32 v21, 0xffff0000, v25
    v_add_f32 v18, v18, v20
    v_add_f32 v19, v19, v21
    v_cvt_pk_bf16_f32 v13, v18, v19
    buffer_store_dwordx2 v[12:13], v10, s[20:23], 0 offen offset:0
    s_nop 0
    buffer_load_dwordx2 v[16:17], v11, s[12:15], 0 offen offset:16
    buffer_load_dwordx2 v[24:25], v14, s[8:11], 0 offen offset:16
    v_cvt_pk_bf16_f32 v12, v68, v69
    v_cvt_pk_bf16_f32 v13, v70, v71
    s_waitcnt vmcnt(0)
    v_lshlrev_b32 v18, 16, v12
    v_and_b32 v19, 0xffff0000, v12
    v_lshlrev_b32 v20, 16, v16
    v_and_b32 v21, 0xffff0000, v16
    v_add_f32 v18, v18, v20
    v_add_f32 v19, v19, v21
    v_cvt_pk_bf16_f32 v22, v18, v19
    v_lshlrev_b32 v18, 16, v22
    v_and_b32 v19, 0xffff0000, v22
    v_lshlrev_b32 v20, 16, v24
    v_and_b32 v21, 0xffff0000, v24
    v_add_f32 v18, v18, v20
    v_add_f32 v19, v19, v21
    v_cvt_pk_bf16_f32 v12, v18, v19
    v_lshlrev_b32 v18, 16, v13
    v_and_b32 v19, 0xffff0000, v13
    v_lshlrev_b32 v20, 16, v17
    v_and_b32 v21, 0xffff0000, v17
    v_add_f32 v18, v18, v20
    v_add_f32 v19, v19, v21
    v_cvt_pk_bf16_f32 v22, v18, v19
    v_lshlrev_b32 v18, 16, v22
    v_and_b32 v19, 0xffff0000, v22
    v_lshlrev_b32 v20, 16, v25
    v_and_b32 v21, 0xffff0000, v25
    v_add_f32 v18, v18, v20
    v_add_f32 v19, v19, v21
    v_cvt_pk_bf16_f32 v13, v18, v19
    buffer_store_dwordx2 v[12:13], v10, s[20:23], 0 offen offset:16
    s_nop 0
    buffer_load_dwordx2 v[16:17], v11, s[12:15], 0 offen offset:32
    buffer_load_dwordx2 v[24:25], v14, s[8:11], 0 offen offset:32
    v_cvt_pk_bf16_f32 v12, v72, v73
    v_cvt_pk_bf16_f32 v13, v74, v75
    s_waitcnt vmcnt(0)
    v_lshlrev_b32 v18, 16, v12
    v_and_b32 v19, 0xffff0000, v12
    v_lshlrev_b32 v20, 16, v16
    v_and_b32 v21, 0xffff0000, v16
    v_add_f32 v18, v18, v20
    v_add_f32 v19, v19, v21
    v_cvt_pk_bf16_f32 v22, v18, v19
    v_lshlrev_b32 v18, 16, v22
    v_and_b32 v19, 0xffff0000, v22
    v_lshlrev_b32 v20, 16, v24
    v_and_b32 v21, 0xffff0000, v24
    v_add_f32 v18, v18, v20
    v_add_f32 v19, v19, v21
    v_cvt_pk_bf16_f32 v12, v18, v19
    v_lshlrev_b32 v18, 16, v13
    v_and_b32 v19, 0xffff0000, v13
    v_lshlrev_b32 v20, 16, v17
    v_and_b32 v21, 0xffff0000, v17
    v_add_f32 v18, v18, v20
    v_add_f32 v19, v19, v21
    v_cvt_pk_bf16_f32 v22, v18, v19
    v_lshlrev_b32 v18, 16, v22
    v_and_b32 v19, 0xffff0000, v22
    v_lshlrev_b32 v20, 16, v25
    v_and_b32 v21, 0xffff0000, v25
    v_add_f32 v18, v18, v20
    v_add_f32 v19, v19, v21
    v_cvt_pk_bf16_f32 v13, v18, v19
    buffer_store_dwordx2 v[12:13], v10, s[20:23], 0 offen offset:32
    s_nop 0
    buffer_load_dwordx2 v[16:17], v11, s[12:15], 0 offen offset:48
    buffer_load_dwordx2 v[24:25], v14, s[8:11], 0 offen offset:48
    v_cvt_pk_bf16_f32 v12, v76, v77
    v_cvt_pk_bf16_f32 v13, v78, v79
    s_waitcnt vmcnt(0)
    v_lshlrev_b32 v18, 16, v12
    v_and_b32 v19, 0xffff0000, v12
    v_lshlrev_b32 v20, 16, v16
    v_and_b32 v21, 0xffff0000, v16
    v_add_f32 v18, v18, v20
    v_add_f32 v19, v19, v21
    v_cvt_pk_bf16_f32 v22, v18, v19
    v_lshlrev_b32 v18, 16, v22
    v_and_b32 v19, 0xffff0000, v22
    v_lshlrev_b32 v20, 16, v24
    v_and_b32 v21, 0xffff0000, v24
    v_add_f32 v18, v18, v20
    v_add_f32 v19, v19, v21
    v_cvt_pk_bf16_f32 v12, v18, v19
    v_lshlrev_b32 v18, 16, v13
    v_and_b32 v19, 0xffff0000, v13
    v_lshlrev_b32 v20, 16, v17
    v_and_b32 v21, 0xffff0000, v17
    v_add_f32 v18, v18, v20
    v_add_f32 v19, v19, v21
    v_cvt_pk_bf16_f32 v22, v18, v19
    v_lshlrev_b32 v18, 16, v22
    v_and_b32 v19, 0xffff0000, v22
    v_lshlrev_b32 v20, 16, v25
    v_and_b32 v21, 0xffff0000, v25
    v_add_f32 v18, v18, v20
    v_add_f32 v19, v19, v21
    v_cvt_pk_bf16_f32 v13, v18, v19
    buffer_store_dwordx2 v[12:13], v10, s[20:23], 0 offen offset:48
    s_nop 0
Lm2_end:
    s_endpgm
.section .rodata,"a"
.p2align 6
.amdhsa_kernel sequential_preLN__memory_aug_recurrent_mem_tr__mixer_channel_mlp__prompt_prep_kernel
  .amdhsa_next_free_vgpr 64
  .amdhsa_next_free_sgpr 102
  .amdhsa_accum_offset 64
  .amdhsa_group_segment_fixed_size 0
  .amdhsa_kernarg_size 120
  .amdhsa_user_sgpr_count 2
  .amdhsa_user_sgpr_kernarg_segment_ptr 1
  .amdhsa_system_sgpr_workgroup_id_x 1
.end_amdhsa_kernel
.p2align 6
.amdhsa_kernel sequential_preLN__memory_aug_recurrent_mem_tr__mixer_channel_mlp__prompt_qkv_kernel
  .amdhsa_next_free_vgpr 208
  .amdhsa_next_free_sgpr 102
  .amdhsa_accum_offset 208
  .amdhsa_group_segment_fixed_size 0
  .amdhsa_kernarg_size 120
  .amdhsa_user_sgpr_count 2
  .amdhsa_user_sgpr_kernarg_segment_ptr 1
  .amdhsa_system_sgpr_workgroup_id_x 1
.end_amdhsa_kernel
.p2align 6
.amdhsa_kernel sequential_preLN__memory_aug_recurrent_mem_tr__mixer_channel_mlp__prompt_chain_kernel
  .amdhsa_next_free_vgpr 256
  .amdhsa_next_free_sgpr 102
  .amdhsa_accum_offset 256
  .amdhsa_group_segment_fixed_size 0
  .amdhsa_kernarg_size 120
  .amdhsa_user_sgpr_count 2
  .amdhsa_user_sgpr_kernarg_segment_ptr 1
  .amdhsa_system_sgpr_workgroup_id_x 1
.end_amdhsa_kernel
.p2align 6
.amdhsa_kernel sequential_preLN__memory_aug_recurrent_mem_tr__mixer_channel_mlp__prompt_attn_kernel
  .amdhsa_next_free_vgpr 224
  .amdhsa_next_free_sgpr 102
  .amdhsa_accum_offset 224
  .amdhsa_group_segment_fixed_size 0
  .amdhsa_kernarg_size 120
  .amdhsa_user_sgpr_count 2
  .amdhsa_user_sgpr_kernarg_segment_ptr 1
  .amdhsa_system_sgpr_workgroup_id_x 1
.end_amdhsa_kernel
.p2align 6
.amdhsa_kernel sequential_preLN__memory_aug_recurrent_mem_tr__mixer_channel_mlp__prompt_wo_kernel
  .amdhsa_next_free_vgpr 208
  .amdhsa_next_free_sgpr 102
  .amdhsa_accum_offset 208
  .amdhsa_group_segment_fixed_size 0
  .amdhsa_kernarg_size 120
  .amdhsa_user_sgpr_count 2
  .amdhsa_user_sgpr_kernarg_segment_ptr 1
  .amdhsa_system_sgpr_workgroup_id_x 1
.end_amdhsa_kernel
.p2align 6
.amdhsa_kernel sequential_preLN__memory_aug_recurrent_mem_tr__mixer_channel_mlp__prompt_ln2_kernel
  .amdhsa_next_free_vgpr 64
  .amdhsa_next_free_sgpr 102
  .amdhsa_accum_offset 64
  .amdhsa_group_segment_fixed_size 0
  .amdhsa_kernarg_size 120
  .amdhsa_user_sgpr_count 2
  .amdhsa_user_sgpr_kernarg_segment_ptr 1
  .amdhsa_system_sgpr_workgroup_id_x 1
.end_amdhsa_kernel
.p2align 6
.amdhsa_kernel sequential_preLN__memory_aug_recurrent_mem_tr__mixer_channel_mlp__prompt_mlp1_kernel
  .amdhsa_next_free_vgpr 208
  .amdhsa_next_free_sgpr 102
  .amdhsa_accum_offset 208
  .amdhsa_group_segment_fixed_size 0
  .amdhsa_kernarg_size 120
  .amdhsa_user_sgpr_count 2
  .amdhsa_user_sgpr_kernarg_segment_ptr 1
  .amdhsa_system_sgpr_workgroup_id_x 1
.end_amdhsa_kernel
.p2align 6
.amdhsa_kernel sequential_preLN__memory_aug_recurrent_mem_tr__mixer_channel_mlp__prompt_mlp2_kernel
  .amdhsa_next_free_vgpr 208
  .amdhsa_next_free_sgpr 102
  .amdhsa_accum_offset 208
  .amdhsa_group_segment_fixed_size 0
  .amdhsa_kernarg_size 120
  .amdhsa_user_sgpr_count 2
  .amdhsa_user_sgpr_kernarg_segment_ptr 1
  .amdhsa_system_sgpr_workgroup_id_x 1
.end_amdhsa_kernel
```
